```python
import torch

def _softmax(x, axis=-1):
    return torch.softmax(x, dim=axis)
def _gelu(x):
    return torch.nn.functional.gelu(x, approximate="tanh")
def _silu(x):
    return torch.nn.functional.silu(x)
def _sigmoid(x):
    return torch.sigmoid(x)
def _layernorm(x, axis=-1, eps=1e-5):
    m = x.mean(dim=axis, keepdim=True)
    v = x.var(dim=axis, keepdim=True, unbiased=False)
    return (x - m) / torch.sqrt(v + eps)
def _scatter_add(tgt, idx, src, axis=0):
    return tgt.clone().index_add_(axis, idx, src)
def _segment_sum(src, seg, n):
    out = torch.zeros((n,) + src.shape[1:], dtype=src.dtype)
    return out.index_add_(0, seg, src)
def _pad(x, pw):
    flat = tuple(v for pair in reversed(pw) for v in pair)
    return torch.nn.functional.pad(x, flat)

kernel_name = 'concat_heads__sliding_block_cached__sliding_block_cached__decode'

def setup_inputs():

    _w = (lambda a: (lambda t: t.to(torch.bfloat16) if t.is_floating_point() else t)(torch.as_tensor(a)))
    def _A_setup():
        B, Sq, D = 4, 1, 512
        Hq, Hkv, Sk, Dh = 32, 8, 8192, 128
        assert Hq % Hkv == 0, (Hq, Hkv)
        return {
            "x": _w((lambda *s: torch.randn(*s, dtype=torch.bfloat16) * 0.8)(B, Sq, D)),
            "k_cache": _w((lambda *s: torch.randn(*s, dtype=torch.bfloat16) * 1.6)(B, Hkv, Sk, Dh)),
            "v_cache": _w((lambda *s: torch.randn(*s, dtype=torch.bfloat16) * 0.2)(B, Hkv, Sk, Dh)),
            "wq": _w((lambda *s: torch.randn(*s, dtype=torch.bfloat16) * 1.6)(D, Hq * Dh) * (D ** -0.5)),
            "wo": _w((lambda *s: torch.randn(*s, dtype=torch.bfloat16) * 0.2)(Hq * Dh, D) * ((Hq * Dh) ** -0.5)),
        }
    _A_in = _A_setup()

    def _B_setup():
        B, Sq, D = 4, 1, 512
        Hq, Hkv, Sk, Dh = 32, 8, 8192, 128
        assert Hq % Hkv == 0, (Hq, Hkv)
        return {
            "x": _w((lambda *s: torch.randn(*s, dtype=torch.bfloat16) * 0.8)(B, Sq, D)),
            "k_cache": _w((lambda *s: torch.randn(*s, dtype=torch.bfloat16) * 1.6)(B, Hkv, Sk, Dh)),
            "v_cache": _w((lambda *s: torch.randn(*s, dtype=torch.bfloat16) * 0.2)(B, Hkv, Sk, Dh)),
            "wq": _w((lambda *s: torch.randn(*s, dtype=torch.bfloat16) * 1.6)(D, Hq * Dh) * (D ** -0.5)),
            "wo": _w((lambda *s: torch.randn(*s, dtype=torch.bfloat16) * 0.2)(Hq * Dh, D) * ((Hq * Dh) ** -0.5)),
        }
    _B_in = _B_setup()

    return {
        "A_x": _A_in["x"],
        "A_k_cache": _A_in["k_cache"],
        "A_v_cache": _A_in["v_cache"],
        "A_wq": _A_in["wq"],
        "A_wo": _A_in["wo"],
        "B_x": _B_in["x"],
        "B_k_cache": _B_in["k_cache"],
        "B_v_cache": _B_in["v_cache"],
        "B_wq": _B_in["wq"],
        "B_wo": _B_in["wo"],
    }

def reference(A_x, A_k_cache, A_v_cache, A_wq, A_wo, B_x, B_k_cache, B_v_cache, B_wq, B_wo):
    def _A_ref(x, k_cache, v_cache, wq, wo):
        B, Sq, D = x.shape
        Hq, Dh = 32, 128
        Hkv, Sk = k_cache.shape[1], k_cache.shape[2]
        W = min(4096, max(256, Sk // 4))
        rep = Hq // Hkv
        q = (lambda x, *d: x.permute(*d))((x @ wq).reshape(B, Sq, Hq, Dh), 0, 2, 1, 3)
        k = (lambda x, n, axis: torch.repeat_interleave(x, n, dim=axis))(k_cache[:, :, Sk - W:, :], rep, axis=1)
        v = (lambda x, n, axis: torch.repeat_interleave(x, n, dim=axis))(v_cache[:, :, Sk - W:, :], rep, axis=1)
        scores = torch.einsum("bhqd,bhkd->bhqk", q, k) * (Dh ** -0.5)
        p = _softmax(scores, axis=-1)
        o = torch.einsum("bhqk,bhkd->bhqd", p, v)
        return (lambda x, *d: x.permute(*d))(o, 0, 2, 1, 3).reshape(B, Sq, Hq * Dh) @ wo

    def _B_ref(x, k_cache, v_cache, wq, wo):
        B, Sq, D = x.shape
        Hq, Dh = 32, 128
        Hkv, Sk = k_cache.shape[1], k_cache.shape[2]
        W = min(4096, max(256, Sk // 4))
        rep = Hq // Hkv
        q = (lambda x, *d: x.permute(*d))((x @ wq).reshape(B, Sq, Hq, Dh), 0, 2, 1, 3)
        k = (lambda x, n, axis: torch.repeat_interleave(x, n, dim=axis))(k_cache[:, :, Sk - W:, :], rep, axis=1)
        v = (lambda x, n, axis: torch.repeat_interleave(x, n, dim=axis))(v_cache[:, :, Sk - W:, :], rep, axis=1)
        scores = torch.einsum("bhqd,bhkd->bhqk", q, k) * (Dh ** -0.5)
        p = _softmax(scores, axis=-1)
        o = torch.einsum("bhqk,bhkd->bhqd", p, v)
        return (lambda x, *d: x.permute(*d))(o, 0, 2, 1, 3).reshape(B, Sq, Hq * Dh) @ wo

    a = _A_ref(A_x, A_k_cache, A_v_cache, A_wq, A_wo)
    b = _B_ref(B_x, B_k_cache, B_v_cache, B_wq, B_wo)
    return torch.concatenate([a, b], axis=-1)
```

```asm
; @launch kernel=qproj_kernel grid=(256,1,1) block=(256,1,1) lds=32768
; @launch kernel=attn_kernel grid=(512,1,1) block=(256,1,1) lds=40960
; @launch kernel=oproj_kernel grid=(256,1,1) block=(256,1,1) lds=36864
.amdgcn_target "amdgcn-amd-amdhsa--gfx950"
.text
.globl qproj_kernel
.p2align 8
.type qproj_kernel,@function
qproj_kernel:
    s_cmp_ge_u32 s2, 256
    s_cbranch_scc1 L_q_end
    s_load_dwordx2 s[4:5], s[0:1], 0
    s_load_dwordx2 s[6:7], s[0:1], 40
    s_load_dwordx2 s[8:9], s[0:1], 24
    s_load_dwordx2 s[10:11], s[0:1], 64
    s_load_dwordx2 s[12:13], s[0:1], 96
    s_lshr_b32 s14, s2, 7
    s_lshr_b32 s15, s2, 5
    s_and_b32 s15, s15, 3
    s_and_b32 s16, s2, 31
    v_and_b32 v1, 15, v0
    v_lshrrev_b32 v2, 4, v0
    s_lshl_b32 s17, s15, 7
    v_lshlrev_b32 v3, 3, v2
    v_add_u32 v3, s17, v3
    v_lshlrev_b32 v4, 1, v3
    v_lshlrev_b32 v5, 13, v3
    s_lshl_b32 s18, s16, 8
    v_lshlrev_b32 v6, 4, v1
    v_add3_u32 v5, v5, s18, v6
    s_waitcnt lgkmcnt(0)
    s_cmp_eq_u32 s14, 0
    s_cselect_b64 s[4:5], s[4:5], s[6:7]
    s_cselect_b64 s[8:9], s[8:9], s[10:11]
    v_mov_b32 v8, v5
    v_add_u32 v9, 8192, v5
    v_add_u32 v10, 16384, v5
    v_add_u32 v11, 24576, v5
    v_add_u32 v12, 32768, v5
    v_add_u32 v13, 40960, v5
    v_add_u32 v14, 49152, v5
    v_add_u32 v15, 57344, v5
    global_load_dwordx4 v[16:19], v8, s[8:9] nt
    global_load_dwordx4 v[20:23], v9, s[8:9] nt
    global_load_dwordx4 v[24:27], v10, s[8:9] nt
    global_load_dwordx4 v[28:31], v11, s[8:9] nt
    global_load_dwordx4 v[32:35], v12, s[8:9] nt
    global_load_dwordx4 v[36:39], v13, s[8:9] nt
    global_load_dwordx4 v[40:43], v14, s[8:9] nt
    global_load_dwordx4 v[44:47], v15, s[8:9] nt
    global_load_dwordx4 v[48:51], v4, s[4:5] offset:0
    global_load_dwordx4 v[52:55], v4, s[4:5] offset:1024
    global_load_dwordx4 v[56:59], v4, s[4:5] offset:2048
    global_load_dwordx4 v[60:63], v4, s[4:5] offset:3072
    v_mov_b32 v96, 0
    v_mov_b32 v97, 0
    v_mov_b32 v98, 0
    v_mov_b32 v99, 0
    v_mov_b32 v100, 0
    v_mov_b32 v101, 0
    v_mov_b32 v102, 0
    v_mov_b32 v103, 0
    v_mov_b32 v104, 0
    v_mov_b32 v105, 0
    v_mov_b32 v106, 0
    v_mov_b32 v107, 0
    v_mov_b32 v108, 0
    v_mov_b32 v109, 0
    v_mov_b32 v110, 0
    v_mov_b32 v111, 0
    v_mov_b32 v112, 0
    v_mov_b32 v113, 0
    v_mov_b32 v114, 0
    v_mov_b32 v115, 0
    v_mov_b32 v116, 0
    v_mov_b32 v117, 0
    v_mov_b32 v118, 0
    v_mov_b32 v119, 0
    v_mov_b32 v120, 0
    v_mov_b32 v121, 0
    v_mov_b32 v122, 0
    v_mov_b32 v123, 0
    v_mov_b32 v124, 0
    v_mov_b32 v125, 0
    v_mov_b32 v126, 0
    v_mov_b32 v127, 0
    s_waitcnt vmcnt(0)
    v_lshlrev_b32 v64, 16, v48
    v_and_b32 v65, 0xffff0000, v48
    v_lshlrev_b32 v66, 16, v49
    v_and_b32 v67, 0xffff0000, v49
    v_lshlrev_b32 v68, 16, v50
    v_and_b32 v69, 0xffff0000, v50
    v_lshlrev_b32 v70, 16, v51
    v_and_b32 v71, 0xffff0000, v51
    v_lshlrev_b32 v72, 16, v52
    v_and_b32 v73, 0xffff0000, v52
    v_lshlrev_b32 v74, 16, v53
    v_and_b32 v75, 0xffff0000, v53
    v_lshlrev_b32 v76, 16, v54
    v_and_b32 v77, 0xffff0000, v54
    v_lshlrev_b32 v78, 16, v55
    v_and_b32 v79, 0xffff0000, v55
    v_lshlrev_b32 v80, 16, v56
    v_and_b32 v81, 0xffff0000, v56
    v_lshlrev_b32 v82, 16, v57
    v_and_b32 v83, 0xffff0000, v57
    v_lshlrev_b32 v84, 16, v58
    v_and_b32 v85, 0xffff0000, v58
    v_lshlrev_b32 v86, 16, v59
    v_and_b32 v87, 0xffff0000, v59
    v_lshlrev_b32 v88, 16, v60
    v_and_b32 v89, 0xffff0000, v60
    v_lshlrev_b32 v90, 16, v61
    v_and_b32 v91, 0xffff0000, v61
    v_lshlrev_b32 v92, 16, v62
    v_and_b32 v93, 0xffff0000, v62
    v_lshlrev_b32 v94, 16, v63
    v_and_b32 v95, 0xffff0000, v63
    v_lshlrev_b32 v128, 16, v16
    v_and_b32 v129, 0xffff0000, v16
    v_lshlrev_b32 v130, 16, v17
    v_and_b32 v131, 0xffff0000, v17
    v_lshlrev_b32 v132, 16, v18
    v_and_b32 v133, 0xffff0000, v18
    v_lshlrev_b32 v134, 16, v19
    v_and_b32 v135, 0xffff0000, v19
    v_pk_fma_f32 v[96:97], v[128:129], v[64:65], v[96:97] op_sel:[0,0,0] op_sel_hi:[1,0,1]
    v_pk_fma_f32 v[98:99], v[130:131], v[64:65], v[98:99] op_sel:[0,0,0] op_sel_hi:[1,0,1]
    v_pk_fma_f32 v[100:101], v[132:133], v[64:65], v[100:101] op_sel:[0,0,0] op_sel_hi:[1,0,1]
    v_pk_fma_f32 v[102:103], v[134:135], v[64:65], v[102:103] op_sel:[0,0,0] op_sel_hi:[1,0,1]
    v_pk_fma_f32 v[104:105], v[128:129], v[72:73], v[104:105] op_sel:[0,0,0] op_sel_hi:[1,0,1]
    v_pk_fma_f32 v[106:107], v[130:131], v[72:73], v[106:107] op_sel:[0,0,0] op_sel_hi:[1,0,1]
    v_pk_fma_f32 v[108:109], v[132:133], v[72:73], v[108:109] op_sel:[0,0,0] op_sel_hi:[1,0,1]
    v_pk_fma_f32 v[110:111], v[134:135], v[72:73], v[110:111] op_sel:[0,0,0] op_sel_hi:[1,0,1]
    v_pk_fma_f32 v[112:113], v[128:129], v[80:81], v[112:113] op_sel:[0,0,0] op_sel_hi:[1,0,1]
    v_pk_fma_f32 v[114:115], v[130:131], v[80:81], v[114:115] op_sel:[0,0,0] op_sel_hi:[1,0,1]
    v_pk_fma_f32 v[116:117], v[132:133], v[80:81], v[116:117] op_sel:[0,0,0] op_sel_hi:[1,0,1]
    v_pk_fma_f32 v[118:119], v[134:135], v[80:81], v[118:119] op_sel:[0,0,0] op_sel_hi:[1,0,1]
    v_pk_fma_f32 v[120:121], v[128:129], v[88:89], v[120:121] op_sel:[0,0,0] op_sel_hi:[1,0,1]
    v_pk_fma_f32 v[122:123], v[130:131], v[88:89], v[122:123] op_sel:[0,0,0] op_sel_hi:[1,0,1]
    v_pk_fma_f32 v[124:125], v[132:133], v[88:89], v[124:125] op_sel:[0,0,0] op_sel_hi:[1,0,1]
    v_pk_fma_f32 v[126:127], v[134:135], v[88:89], v[126:127] op_sel:[0,0,0] op_sel_hi:[1,0,1]
    v_lshlrev_b32 v128, 16, v20
    v_and_b32 v129, 0xffff0000, v20
    v_lshlrev_b32 v130, 16, v21
    v_and_b32 v131, 0xffff0000, v21
    v_lshlrev_b32 v132, 16, v22
    v_and_b32 v133, 0xffff0000, v22
    v_lshlrev_b32 v134, 16, v23
    v_and_b32 v135, 0xffff0000, v23
    v_pk_fma_f32 v[96:97], v[128:129], v[64:65], v[96:97] op_sel:[0,1,0] op_sel_hi:[1,1,1]
    v_pk_fma_f32 v[98:99], v[130:131], v[64:65], v[98:99] op_sel:[0,1,0] op_sel_hi:[1,1,1]
    v_pk_fma_f32 v[100:101], v[132:133], v[64:65], v[100:101] op_sel:[0,1,0] op_sel_hi:[1,1,1]
    v_pk_fma_f32 v[102:103], v[134:135], v[64:65], v[102:103] op_sel:[0,1,0] op_sel_hi:[1,1,1]
    v_pk_fma_f32 v[104:105], v[128:129], v[72:73], v[104:105] op_sel:[0,1,0] op_sel_hi:[1,1,1]
    v_pk_fma_f32 v[106:107], v[130:131], v[72:73], v[106:107] op_sel:[0,1,0] op_sel_hi:[1,1,1]
    v_pk_fma_f32 v[108:109], v[132:133], v[72:73], v[108:109] op_sel:[0,1,0] op_sel_hi:[1,1,1]
    v_pk_fma_f32 v[110:111], v[134:135], v[72:73], v[110:111] op_sel:[0,1,0] op_sel_hi:[1,1,1]
    v_pk_fma_f32 v[112:113], v[128:129], v[80:81], v[112:113] op_sel:[0,1,0] op_sel_hi:[1,1,1]
    v_pk_fma_f32 v[114:115], v[130:131], v[80:81], v[114:115] op_sel:[0,1,0] op_sel_hi:[1,1,1]
    v_pk_fma_f32 v[116:117], v[132:133], v[80:81], v[116:117] op_sel:[0,1,0] op_sel_hi:[1,1,1]
    v_pk_fma_f32 v[118:119], v[134:135], v[80:81], v[118:119] op_sel:[0,1,0] op_sel_hi:[1,1,1]
    v_pk_fma_f32 v[120:121], v[128:129], v[88:89], v[120:121] op_sel:[0,1,0] op_sel_hi:[1,1,1]
    v_pk_fma_f32 v[122:123], v[130:131], v[88:89], v[122:123] op_sel:[0,1,0] op_sel_hi:[1,1,1]
    v_pk_fma_f32 v[124:125], v[132:133], v[88:89], v[124:125] op_sel:[0,1,0] op_sel_hi:[1,1,1]
    v_pk_fma_f32 v[126:127], v[134:135], v[88:89], v[126:127] op_sel:[0,1,0] op_sel_hi:[1,1,1]
    v_lshlrev_b32 v128, 16, v24
    v_and_b32 v129, 0xffff0000, v24
    v_lshlrev_b32 v130, 16, v25
    v_and_b32 v131, 0xffff0000, v25
    v_lshlrev_b32 v132, 16, v26
    v_and_b32 v133, 0xffff0000, v26
    v_lshlrev_b32 v134, 16, v27
    v_and_b32 v135, 0xffff0000, v27
    v_pk_fma_f32 v[96:97], v[128:129], v[66:67], v[96:97] op_sel:[0,0,0] op_sel_hi:[1,0,1]
    v_pk_fma_f32 v[98:99], v[130:131], v[66:67], v[98:99] op_sel:[0,0,0] op_sel_hi:[1,0,1]
    v_pk_fma_f32 v[100:101], v[132:133], v[66:67], v[100:101] op_sel:[0,0,0] op_sel_hi:[1,0,1]
    v_pk_fma_f32 v[102:103], v[134:135], v[66:67], v[102:103] op_sel:[0,0,0] op_sel_hi:[1,0,1]
    v_pk_fma_f32 v[104:105], v[128:129], v[74:75], v[104:105] op_sel:[0,0,0] op_sel_hi:[1,0,1]
    v_pk_fma_f32 v[106:107], v[130:131], v[74:75], v[106:107] op_sel:[0,0,0] op_sel_hi:[1,0,1]
    v_pk_fma_f32 v[108:109], v[132:133], v[74:75], v[108:109] op_sel:[0,0,0] op_sel_hi:[1,0,1]
    v_pk_fma_f32 v[110:111], v[134:135], v[74:75], v[110:111] op_sel:[0,0,0] op_sel_hi:[1,0,1]
    v_pk_fma_f32 v[112:113], v[128:129], v[82:83], v[112:113] op_sel:[0,0,0] op_sel_hi:[1,0,1]
    v_pk_fma_f32 v[114:115], v[130:131], v[82:83], v[114:115] op_sel:[0,0,0] op_sel_hi:[1,0,1]
    v_pk_fma_f32 v[116:117], v[132:133], v[82:83], v[116:117] op_sel:[0,0,0] op_sel_hi:[1,0,1]
    v_pk_fma_f32 v[118:119], v[134:135], v[82:83], v[118:119] op_sel:[0,0,0] op_sel_hi:[1,0,1]
    v_pk_fma_f32 v[120:121], v[128:129], v[90:91], v[120:121] op_sel:[0,0,0] op_sel_hi:[1,0,1]
    v_pk_fma_f32 v[122:123], v[130:131], v[90:91], v[122:123] op_sel:[0,0,0] op_sel_hi:[1,0,1]
    v_pk_fma_f32 v[124:125], v[132:133], v[90:91], v[124:125] op_sel:[0,0,0] op_sel_hi:[1,0,1]
    v_pk_fma_f32 v[126:127], v[134:135], v[90:91], v[126:127] op_sel:[0,0,0] op_sel_hi:[1,0,1]
    v_lshlrev_b32 v128, 16, v28
    v_and_b32 v129, 0xffff0000, v28
    v_lshlrev_b32 v130, 16, v29
    v_and_b32 v131, 0xffff0000, v29
    v_lshlrev_b32 v132, 16, v30
    v_and_b32 v133, 0xffff0000, v30
    v_lshlrev_b32 v134, 16, v31
    v_and_b32 v135, 0xffff0000, v31
    v_pk_fma_f32 v[96:97], v[128:129], v[66:67], v[96:97] op_sel:[0,1,0] op_sel_hi:[1,1,1]
    v_pk_fma_f32 v[98:99], v[130:131], v[66:67], v[98:99] op_sel:[0,1,0] op_sel_hi:[1,1,1]
    v_pk_fma_f32 v[100:101], v[132:133], v[66:67], v[100:101] op_sel:[0,1,0] op_sel_hi:[1,1,1]
    v_pk_fma_f32 v[102:103], v[134:135], v[66:67], v[102:103] op_sel:[0,1,0] op_sel_hi:[1,1,1]
    v_pk_fma_f32 v[104:105], v[128:129], v[74:75], v[104:105] op_sel:[0,1,0] op_sel_hi:[1,1,1]
    v_pk_fma_f32 v[106:107], v[130:131], v[74:75], v[106:107] op_sel:[0,1,0] op_sel_hi:[1,1,1]
    v_pk_fma_f32 v[108:109], v[132:133], v[74:75], v[108:109] op_sel:[0,1,0] op_sel_hi:[1,1,1]
    v_pk_fma_f32 v[110:111], v[134:135], v[74:75], v[110:111] op_sel:[0,1,0] op_sel_hi:[1,1,1]
    v_pk_fma_f32 v[112:113], v[128:129], v[82:83], v[112:113] op_sel:[0,1,0] op_sel_hi:[1,1,1]
    v_pk_fma_f32 v[114:115], v[130:131], v[82:83], v[114:115] op_sel:[0,1,0] op_sel_hi:[1,1,1]
    v_pk_fma_f32 v[116:117], v[132:133], v[82:83], v[116:117] op_sel:[0,1,0] op_sel_hi:[1,1,1]
    v_pk_fma_f32 v[118:119], v[134:135], v[82:83], v[118:119] op_sel:[0,1,0] op_sel_hi:[1,1,1]
    v_pk_fma_f32 v[120:121], v[128:129], v[90:91], v[120:121] op_sel:[0,1,0] op_sel_hi:[1,1,1]
    v_pk_fma_f32 v[122:123], v[130:131], v[90:91], v[122:123] op_sel:[0,1,0] op_sel_hi:[1,1,1]
    v_pk_fma_f32 v[124:125], v[132:133], v[90:91], v[124:125] op_sel:[0,1,0] op_sel_hi:[1,1,1]
    v_pk_fma_f32 v[126:127], v[134:135], v[90:91], v[126:127] op_sel:[0,1,0] op_sel_hi:[1,1,1]
    v_lshlrev_b32 v128, 16, v32
    v_and_b32 v129, 0xffff0000, v32
    v_lshlrev_b32 v130, 16, v33
    v_and_b32 v131, 0xffff0000, v33
    v_lshlrev_b32 v132, 16, v34
    v_and_b32 v133, 0xffff0000, v34
    v_lshlrev_b32 v134, 16, v35
    v_and_b32 v135, 0xffff0000, v35
    v_pk_fma_f32 v[96:97], v[128:129], v[68:69], v[96:97] op_sel:[0,0,0] op_sel_hi:[1,0,1]
    v_pk_fma_f32 v[98:99], v[130:131], v[68:69], v[98:99] op_sel:[0,0,0] op_sel_hi:[1,0,1]
    v_pk_fma_f32 v[100:101], v[132:133], v[68:69], v[100:101] op_sel:[0,0,0] op_sel_hi:[1,0,1]
    v_pk_fma_f32 v[102:103], v[134:135], v[68:69], v[102:103] op_sel:[0,0,0] op_sel_hi:[1,0,1]
    v_pk_fma_f32 v[104:105], v[128:129], v[76:77], v[104:105] op_sel:[0,0,0] op_sel_hi:[1,0,1]
    v_pk_fma_f32 v[106:107], v[130:131], v[76:77], v[106:107] op_sel:[0,0,0] op_sel_hi:[1,0,1]
    v_pk_fma_f32 v[108:109], v[132:133], v[76:77], v[108:109] op_sel:[0,0,0] op_sel_hi:[1,0,1]
    v_pk_fma_f32 v[110:111], v[134:135], v[76:77], v[110:111] op_sel:[0,0,0] op_sel_hi:[1,0,1]
    v_pk_fma_f32 v[112:113], v[128:129], v[84:85], v[112:113] op_sel:[0,0,0] op_sel_hi:[1,0,1]
    v_pk_fma_f32 v[114:115], v[130:131], v[84:85], v[114:115] op_sel:[0,0,0] op_sel_hi:[1,0,1]
    v_pk_fma_f32 v[116:117], v[132:133], v[84:85], v[116:117] op_sel:[0,0,0] op_sel_hi:[1,0,1]
    v_pk_fma_f32 v[118:119], v[134:135], v[84:85], v[118:119] op_sel:[0,0,0] op_sel_hi:[1,0,1]
    v_pk_fma_f32 v[120:121], v[128:129], v[92:93], v[120:121] op_sel:[0,0,0] op_sel_hi:[1,0,1]
    v_pk_fma_f32 v[122:123], v[130:131], v[92:93], v[122:123] op_sel:[0,0,0] op_sel_hi:[1,0,1]
    v_pk_fma_f32 v[124:125], v[132:133], v[92:93], v[124:125] op_sel:[0,0,0] op_sel_hi:[1,0,1]
    v_pk_fma_f32 v[126:127], v[134:135], v[92:93], v[126:127] op_sel:[0,0,0] op_sel_hi:[1,0,1]
    v_lshlrev_b32 v128, 16, v36
    v_and_b32 v129, 0xffff0000, v36
    v_lshlrev_b32 v130, 16, v37
    v_and_b32 v131, 0xffff0000, v37
    v_lshlrev_b32 v132, 16, v38
    v_and_b32 v133, 0xffff0000, v38
    v_lshlrev_b32 v134, 16, v39
    v_and_b32 v135, 0xffff0000, v39
    v_pk_fma_f32 v[96:97], v[128:129], v[68:69], v[96:97] op_sel:[0,1,0] op_sel_hi:[1,1,1]
    v_pk_fma_f32 v[98:99], v[130:131], v[68:69], v[98:99] op_sel:[0,1,0] op_sel_hi:[1,1,1]
    v_pk_fma_f32 v[100:101], v[132:133], v[68:69], v[100:101] op_sel:[0,1,0] op_sel_hi:[1,1,1]
    v_pk_fma_f32 v[102:103], v[134:135], v[68:69], v[102:103] op_sel:[0,1,0] op_sel_hi:[1,1,1]
    v_pk_fma_f32 v[104:105], v[128:129], v[76:77], v[104:105] op_sel:[0,1,0] op_sel_hi:[1,1,1]
    v_pk_fma_f32 v[106:107], v[130:131], v[76:77], v[106:107] op_sel:[0,1,0] op_sel_hi:[1,1,1]
    v_pk_fma_f32 v[108:109], v[132:133], v[76:77], v[108:109] op_sel:[0,1,0] op_sel_hi:[1,1,1]
    v_pk_fma_f32 v[110:111], v[134:135], v[76:77], v[110:111] op_sel:[0,1,0] op_sel_hi:[1,1,1]
    v_pk_fma_f32 v[112:113], v[128:129], v[84:85], v[112:113] op_sel:[0,1,0] op_sel_hi:[1,1,1]
    v_pk_fma_f32 v[114:115], v[130:131], v[84:85], v[114:115] op_sel:[0,1,0] op_sel_hi:[1,1,1]
    v_pk_fma_f32 v[116:117], v[132:133], v[84:85], v[116:117] op_sel:[0,1,0] op_sel_hi:[1,1,1]
    v_pk_fma_f32 v[118:119], v[134:135], v[84:85], v[118:119] op_sel:[0,1,0] op_sel_hi:[1,1,1]
    v_pk_fma_f32 v[120:121], v[128:129], v[92:93], v[120:121] op_sel:[0,1,0] op_sel_hi:[1,1,1]
    v_pk_fma_f32 v[122:123], v[130:131], v[92:93], v[122:123] op_sel:[0,1,0] op_sel_hi:[1,1,1]
    v_pk_fma_f32 v[124:125], v[132:133], v[92:93], v[124:125] op_sel:[0,1,0] op_sel_hi:[1,1,1]
    v_pk_fma_f32 v[126:127], v[134:135], v[92:93], v[126:127] op_sel:[0,1,0] op_sel_hi:[1,1,1]
    v_lshlrev_b32 v128, 16, v40
    v_and_b32 v129, 0xffff0000, v40
    v_lshlrev_b32 v130, 16, v41
    v_and_b32 v131, 0xffff0000, v41
    v_lshlrev_b32 v132, 16, v42
    v_and_b32 v133, 0xffff0000, v42
    v_lshlrev_b32 v134, 16, v43
    v_and_b32 v135, 0xffff0000, v43
    v_pk_fma_f32 v[96:97], v[128:129], v[70:71], v[96:97] op_sel:[0,0,0] op_sel_hi:[1,0,1]
    v_pk_fma_f32 v[98:99], v[130:131], v[70:71], v[98:99] op_sel:[0,0,0] op_sel_hi:[1,0,1]
    v_pk_fma_f32 v[100:101], v[132:133], v[70:71], v[100:101] op_sel:[0,0,0] op_sel_hi:[1,0,1]
    v_pk_fma_f32 v[102:103], v[134:135], v[70:71], v[102:103] op_sel:[0,0,0] op_sel_hi:[1,0,1]
    v_pk_fma_f32 v[104:105], v[128:129], v[78:79], v[104:105] op_sel:[0,0,0] op_sel_hi:[1,0,1]
    v_pk_fma_f32 v[106:107], v[130:131], v[78:79], v[106:107] op_sel:[0,0,0] op_sel_hi:[1,0,1]
    v_pk_fma_f32 v[108:109], v[132:133], v[78:79], v[108:109] op_sel:[0,0,0] op_sel_hi:[1,0,1]
    v_pk_fma_f32 v[110:111], v[134:135], v[78:79], v[110:111] op_sel:[0,0,0] op_sel_hi:[1,0,1]
    v_pk_fma_f32 v[112:113], v[128:129], v[86:87], v[112:113] op_sel:[0,0,0] op_sel_hi:[1,0,1]
    v_pk_fma_f32 v[114:115], v[130:131], v[86:87], v[114:115] op_sel:[0,0,0] op_sel_hi:[1,0,1]
    v_pk_fma_f32 v[116:117], v[132:133], v[86:87], v[116:117] op_sel:[0,0,0] op_sel_hi:[1,0,1]
    v_pk_fma_f32 v[118:119], v[134:135], v[86:87], v[118:119] op_sel:[0,0,0] op_sel_hi:[1,0,1]
    v_pk_fma_f32 v[120:121], v[128:129], v[94:95], v[120:121] op_sel:[0,0,0] op_sel_hi:[1,0,1]
    v_pk_fma_f32 v[122:123], v[130:131], v[94:95], v[122:123] op_sel:[0,0,0] op_sel_hi:[1,0,1]
    v_pk_fma_f32 v[124:125], v[132:133], v[94:95], v[124:125] op_sel:[0,0,0] op_sel_hi:[1,0,1]
    v_pk_fma_f32 v[126:127], v[134:135], v[94:95], v[126:127] op_sel:[0,0,0] op_sel_hi:[1,0,1]
    v_lshlrev_b32 v128, 16, v44
    v_and_b32 v129, 0xffff0000, v44
    v_lshlrev_b32 v130, 16, v45
    v_and_b32 v131, 0xffff0000, v45
    v_lshlrev_b32 v132, 16, v46
    v_and_b32 v133, 0xffff0000, v46
    v_lshlrev_b32 v134, 16, v47
    v_and_b32 v135, 0xffff0000, v47
    v_pk_fma_f32 v[96:97], v[128:129], v[70:71], v[96:97] op_sel:[0,1,0] op_sel_hi:[1,1,1]
    v_pk_fma_f32 v[98:99], v[130:131], v[70:71], v[98:99] op_sel:[0,1,0] op_sel_hi:[1,1,1]
    v_pk_fma_f32 v[100:101], v[132:133], v[70:71], v[100:101] op_sel:[0,1,0] op_sel_hi:[1,1,1]
    v_pk_fma_f32 v[102:103], v[134:135], v[70:71], v[102:103] op_sel:[0,1,0] op_sel_hi:[1,1,1]
    v_pk_fma_f32 v[104:105], v[128:129], v[78:79], v[104:105] op_sel:[0,1,0] op_sel_hi:[1,1,1]
    v_pk_fma_f32 v[106:107], v[130:131], v[78:79], v[106:107] op_sel:[0,1,0] op_sel_hi:[1,1,1]
    v_pk_fma_f32 v[108:109], v[132:133], v[78:79], v[108:109] op_sel:[0,1,0] op_sel_hi:[1,1,1]
    v_pk_fma_f32 v[110:111], v[134:135], v[78:79], v[110:111] op_sel:[0,1,0] op_sel_hi:[1,1,1]
    v_pk_fma_f32 v[112:113], v[128:129], v[86:87], v[112:113] op_sel:[0,1,0] op_sel_hi:[1,1,1]
    v_pk_fma_f32 v[114:115], v[130:131], v[86:87], v[114:115] op_sel:[0,1,0] op_sel_hi:[1,1,1]
    v_pk_fma_f32 v[116:117], v[132:133], v[86:87], v[116:117] op_sel:[0,1,0] op_sel_hi:[1,1,1]
    v_pk_fma_f32 v[118:119], v[134:135], v[86:87], v[118:119] op_sel:[0,1,0] op_sel_hi:[1,1,1]
    v_pk_fma_f32 v[120:121], v[128:129], v[94:95], v[120:121] op_sel:[0,1,0] op_sel_hi:[1,1,1]
    v_pk_fma_f32 v[122:123], v[130:131], v[94:95], v[122:123] op_sel:[0,1,0] op_sel_hi:[1,1,1]
    v_pk_fma_f32 v[124:125], v[132:133], v[94:95], v[124:125] op_sel:[0,1,0] op_sel_hi:[1,1,1]
    v_pk_fma_f32 v[126:127], v[134:135], v[94:95], v[126:127] op_sel:[0,1,0] op_sel_hi:[1,1,1]
    v_lshlrev_b32 v7, 11, v2
    v_lshl_add_u32 v7, v1, 5, v7
    ds_write_b128 v7, v[96:99] offset:0
    ds_write_b128 v7, v[100:103] offset:16
    ds_write_b128 v7, v[104:107] offset:512
    ds_write_b128 v7, v[108:111] offset:528
    ds_write_b128 v7, v[112:115] offset:1024
    ds_write_b128 v7, v[116:119] offset:1040
    ds_write_b128 v7, v[120:123] offset:1536
    ds_write_b128 v7, v[124:127] offset:1552
    s_waitcnt lgkmcnt(0)
    s_barrier
    v_lshlrev_b32 v7, 3, v0
    ds_read_b64 v[16:17], v7 offset:0
    ds_read_b64 v[18:19], v7 offset:2048
    ds_read_b64 v[20:21], v7 offset:4096
    ds_read_b64 v[22:23], v7 offset:6144
    ds_read_b64 v[24:25], v7 offset:8192
    ds_read_b64 v[26:27], v7 offset:10240
    ds_read_b64 v[28:29], v7 offset:12288
    ds_read_b64 v[30:31], v7 offset:14336
    ds_read_b64 v[32:33], v7 offset:16384
    ds_read_b64 v[34:35], v7 offset:18432
    ds_read_b64 v[36:37], v7 offset:20480
    ds_read_b64 v[38:39], v7 offset:22528
    ds_read_b64 v[40:41], v7 offset:24576
    ds_read_b64 v[42:43], v7 offset:26624
    ds_read_b64 v[44:45], v7 offset:28672
    ds_read_b64 v[46:47], v7 offset:30720
    s_waitcnt lgkmcnt(14)
    v_pk_add_f32 v[16:17], v[16:17], v[18:19]
    s_waitcnt lgkmcnt(13)
    v_pk_add_f32 v[16:17], v[16:17], v[20:21]
    s_waitcnt lgkmcnt(12)
    v_pk_add_f32 v[16:17], v[16:17], v[22:23]
    s_waitcnt lgkmcnt(11)
    v_pk_add_f32 v[16:17], v[16:17], v[24:25]
    s_waitcnt lgkmcnt(10)
    v_pk_add_f32 v[16:17], v[16:17], v[26:27]
    s_waitcnt lgkmcnt(9)
    v_pk_add_f32 v[16:17], v[16:17], v[28:29]
    s_waitcnt lgkmcnt(8)
    v_pk_add_f32 v[16:17], v[16:17], v[30:31]
    s_waitcnt lgkmcnt(7)
    v_pk_add_f32 v[16:17], v[16:17], v[32:33]
    s_waitcnt lgkmcnt(6)
    v_pk_add_f32 v[16:17], v[16:17], v[34:35]
    s_waitcnt lgkmcnt(5)
    v_pk_add_f32 v[16:17], v[16:17], v[36:37]
    s_waitcnt lgkmcnt(4)
    v_pk_add_f32 v[16:17], v[16:17], v[38:39]
    s_waitcnt lgkmcnt(3)
    v_pk_add_f32 v[16:17], v[16:17], v[40:41]
    s_waitcnt lgkmcnt(2)
    v_pk_add_f32 v[16:17], v[16:17], v[42:43]
    s_waitcnt lgkmcnt(1)
    v_pk_add_f32 v[16:17], v[16:17], v[44:45]
    s_waitcnt lgkmcnt(0)
    v_pk_add_f32 v[16:17], v[16:17], v[46:47]
    s_lshl_b32 s19, s14, 2
    s_add_u32 s19, s19, s15
    s_lshl_b32 s19, s19, 16
    s_lshl_b32 s20, s16, 9
    s_add_u32 s19, s19, s20
    v_lshrrev_b32 v8, 6, v0
    v_lshlrev_b32 v8, 14, v8
    v_and_b32 v9, 63, v0
    v_lshlrev_b32 v9, 3, v9
    v_add3_u32 v8, v8, v9, s19
    global_store_dwordx2 v8, v[16:17], s[12:13]
L_q_end:
    s_endpgm
.globl attn_kernel
.p2align 8
.type attn_kernel,@function
attn_kernel:
    s_cmp_ge_u32 s2, 512
    s_cbranch_scc1 L_a_end
    s_load_dwordx4 s[4:7], s[0:1], 8
    s_load_dwordx4 s[8:11], s[0:1], 48
    s_load_dwordx2 s[12:13], s[0:1], 96
    s_lshr_b32 s14, s2, 8
    s_lshr_b32 s15, s2, 6
    s_and_b32 s15, s15, 3
    s_lshr_b32 s16, s2, 3
    s_and_b32 s16, s16, 7
    s_and_b32 s17, s2, 7
    s_lshl_b32 s18, s15, 3
    s_add_u32 s18, s18, s16
    s_lshl_b32 s18, s18, 13
    s_lshl_b32 s19, s17, 8
    s_add_u32 s18, s18, s19
    s_add_u32 s18, s18, 6144
    s_lshl_b32 s18, s18, 8
    s_lshl_b32 s20, s14, 4
    s_add_u32 s20, s20, s15
    s_lshl_b32 s20, s20, 14
    s_lshl_b32 s21, s16, 11
    s_add_u32 s20, s20, s21
    v_lshrrev_b32 v1, 6, v0
    v_and_b32 v2, 63, v0
    v_lshlrev_b32 v3, 3, v0
    v_add_u32 v3, s20, v3
    v_lshlrev_b32 v4, 14, v1
    v_and_b32 v5, 15, v2
    v_lshlrev_b32 v5, 8, v5
    v_lshrrev_b32 v6, 4, v2
    v_lshlrev_b32 v7, 4, v6
    v_add3_u32 v5, v5, v7, v4
    v_lshl_add_u32 v7, v2, 4, v4
    s_waitcnt lgkmcnt(0)
    s_cmp_eq_u32 s14, 0
    s_cselect_b64 s[4:5], s[4:5], s[8:9]
    s_cselect_b64 s[6:7], s[6:7], s[10:11]
    s_add_u32 s4, s4, s18
    s_addc_u32 s5, s5, 0
    s_add_u32 s6, s6, s18
    s_addc_u32 s7, s7, 0
    v_add_u32 v8, 0x10000, v3
    v_add_u32 v9, 0x20000, v3
    v_add_u32 v10, 0x30000, v3
    global_load_dwordx2 v[160:161], v3, s[12:13]
    global_load_dwordx2 v[162:163], v8, s[12:13]
    global_load_dwordx2 v[164:165], v9, s[12:13]
    global_load_dwordx2 v[166:167], v10, s[12:13]
    v_add_u32 v8, 4096, v5
    v_add_u32 v9, 8192, v5
    v_add_u32 v10, 12288, v5
    global_load_dwordx4 v[32:35], v5, s[4:5] offset:0 nt
    global_load_dwordx4 v[36:39], v5, s[4:5] offset:64 nt
    global_load_dwordx4 v[40:43], v5, s[4:5] offset:128 nt
    global_load_dwordx4 v[44:47], v5, s[4:5] offset:192 nt
    global_load_dwordx4 v[48:51], v8, s[4:5] offset:0 nt
    global_load_dwordx4 v[52:55], v8, s[4:5] offset:64 nt
    global_load_dwordx4 v[56:59], v8, s[4:5] offset:128 nt
    global_load_dwordx4 v[60:63], v8, s[4:5] offset:192 nt
    global_load_dwordx4 v[64:67], v9, s[4:5] offset:0 nt
    global_load_dwordx4 v[68:71], v9, s[4:5] offset:64 nt
    global_load_dwordx4 v[72:75], v9, s[4:5] offset:128 nt
    global_load_dwordx4 v[76:79], v9, s[4:5] offset:192 nt
    global_load_dwordx4 v[80:83], v10, s[4:5] offset:0 nt
    global_load_dwordx4 v[84:87], v10, s[4:5] offset:64 nt
    global_load_dwordx4 v[88:91], v10, s[4:5] offset:128 nt
    global_load_dwordx4 v[92:95], v10, s[4:5] offset:192 nt
    v_add_u32 v11, 4096, v7
    v_add_u32 v12, 8192, v7
    v_add_u32 v13, 12288, v7
    global_load_dwordx4 v[96:99], v7, s[6:7] offset:0 nt
    global_load_dwordx4 v[100:103], v7, s[6:7] offset:1024 nt
    global_load_dwordx4 v[104:107], v7, s[6:7] offset:2048 nt
    global_load_dwordx4 v[108:111], v7, s[6:7] offset:3072 nt
    global_load_dwordx4 v[112:115], v11, s[6:7] offset:0 nt
    global_load_dwordx4 v[116:119], v11, s[6:7] offset:1024 nt
    global_load_dwordx4 v[120:123], v11, s[6:7] offset:2048 nt
    global_load_dwordx4 v[124:127], v11, s[6:7] offset:3072 nt
    global_load_dwordx4 v[128:131], v12, s[6:7] offset:0 nt
    global_load_dwordx4 v[132:135], v12, s[6:7] offset:1024 nt
    global_load_dwordx4 v[136:139], v12, s[6:7] offset:2048 nt
    global_load_dwordx4 v[140:143], v12, s[6:7] offset:3072 nt
    global_load_dwordx4 v[144:147], v13, s[6:7] offset:0 nt
    global_load_dwordx4 v[148:151], v13, s[6:7] offset:1024 nt
    global_load_dwordx4 v[152:155], v13, s[6:7] offset:2048 nt
    global_load_dwordx4 v[156:159], v13, s[6:7] offset:3072 nt
    s_waitcnt vmcnt(32)
    v_pk_add_f32 v[160:161], v[160:161], v[162:163]
    v_pk_add_f32 v[164:165], v[164:165], v[166:167]
    v_pk_add_f32 v[160:161], v[160:161], v[164:165]
    v_cvt_pk_bf16_f32 v160, v160, v161
    v_lshlrev_b32 v8, 2, v0
    ds_write_b32 v8, v160
    s_waitcnt lgkmcnt(0)
    s_barrier
    v_and_b32 v8, 3, v2
    v_lshlrev_b32 v8, 8, v8
    v_lshl_add_u32 v8, v6, 4, v8
    ds_read_b128 v[16:19], v8 offset:0
    ds_read_b128 v[20:23], v8 offset:64
    ds_read_b128 v[24:27], v8 offset:128
    ds_read_b128 v[28:31], v8 offset:192
    v_mov_b32 v160, 0
    v_mov_b32 v161, 0
    v_mov_b32 v162, 0
    v_mov_b32 v163, 0
    v_mov_b32 v164, 0
    v_mov_b32 v165, 0
    v_mov_b32 v166, 0
    v_mov_b32 v167, 0
    v_mov_b32 v168, 0
    v_mov_b32 v169, 0
    v_mov_b32 v170, 0
    v_mov_b32 v171, 0
    v_mov_b32 v172, 0
    v_mov_b32 v173, 0
    v_mov_b32 v174, 0
    v_mov_b32 v175, 0
    s_waitcnt lgkmcnt(0)
    s_waitcnt vmcnt(28)
    v_mfma_f32_16x16x32_bf16 v[160:163], v[16:19], v[32:35], v[160:163]
    v_mfma_f32_16x16x32_bf16 v[160:163], v[20:23], v[36:39], v[160:163]
    v_mfma_f32_16x16x32_bf16 v[160:163], v[24:27], v[40:43], v[160:163]
    v_mfma_f32_16x16x32_bf16 v[160:163], v[28:31], v[44:47], v[160:163]
    s_waitcnt vmcnt(24)
    v_mfma_f32_16x16x32_bf16 v[164:167], v[16:19], v[48:51], v[164:167]
    v_mfma_f32_16x16x32_bf16 v[164:167], v[20:23], v[52:55], v[164:167]
    v_mfma_f32_16x16x32_bf16 v[164:167], v[24:27], v[56:59], v[164:167]
    v_mfma_f32_16x16x32_bf16 v[164:167], v[28:31], v[60:63], v[164:167]
    s_waitcnt vmcnt(20)
    v_mfma_f32_16x16x32_bf16 v[168:171], v[16:19], v[64:67], v[168:171]
    v_mfma_f32_16x16x32_bf16 v[168:171], v[20:23], v[68:71], v[168:171]
    v_mfma_f32_16x16x32_bf16 v[168:171], v[24:27], v[72:75], v[168:171]
    v_mfma_f32_16x16x32_bf16 v[168:171], v[28:31], v[76:79], v[168:171]
    s_waitcnt vmcnt(16)
    v_mfma_f32_16x16x32_bf16 v[172:175], v[16:19], v[80:83], v[172:175]
    v_mfma_f32_16x16x32_bf16 v[172:175], v[20:23], v[84:87], v[172:175]
    v_mfma_f32_16x16x32_bf16 v[172:175], v[24:27], v[88:91], v[172:175]
    v_mfma_f32_16x16x32_bf16 v[172:175], v[28:31], v[92:95], v[172:175]
    s_mov_b32 s22, 0xffff0000
    s_mov_b32 s23, 0
    s_mov_b32 s24, 0
    s_mov_b32 s25, 0x0000ffff
    s_mov_b32 s26, 0
    s_mov_b32 s27, 0xffff0000
    s_nop 7
    s_nop 3
    v_cndmask_b32 v176, v160, v164, s[22:23]
    v_cndmask_b32 v177, v161, v165, s[22:23]
    v_cndmask_b32 v178, v162, v166, s[22:23]
    v_cndmask_b32 v179, v163, v167, s[22:23]
    v_cndmask_b32 v176, v176, v168, s[24:25]
    v_cndmask_b32 v177, v177, v169, s[24:25]
    v_cndmask_b32 v178, v178, v170, s[24:25]
    v_cndmask_b32 v179, v179, v171, s[24:25]
    v_cndmask_b32 v176, v176, v172, s[26:27]
    v_cndmask_b32 v177, v177, v173, s[26:27]
    v_cndmask_b32 v178, v178, v174, s[26:27]
    v_cndmask_b32 v179, v179, v175, s[26:27]
    s_mov_b32 s28, 0x3e0293ee
    v_mul_f32 v176, s28, v176
    v_mul_f32 v177, s28, v177
    v_mul_f32 v178, s28, v178
    v_mul_f32 v179, s28, v179
    v_mov_b32 v180, v176
    v_mov_b32 v181, v177
    v_mov_b32 v182, v178
    v_mov_b32 v183, v179
    s_nop 1
    v_max_f32_dpp v180, v180, v180 quad_perm:[1,0,3,2] row_mask:0xf bank_mask:0xf
    v_max_f32_dpp v181, v181, v181 quad_perm:[1,0,3,2] row_mask:0xf bank_mask:0xf
    v_max_f32_dpp v182, v182, v182 quad_perm:[1,0,3,2] row_mask:0xf bank_mask:0xf
    v_max_f32_dpp v183, v183, v183 quad_perm:[1,0,3,2] row_mask:0xf bank_mask:0xf
    s_nop 1
    v_max_f32_dpp v180, v180, v180 quad_perm:[2,3,0,1] row_mask:0xf bank_mask:0xf
    v_max_f32_dpp v181, v181, v181 quad_perm:[2,3,0,1] row_mask:0xf bank_mask:0xf
    v_max_f32_dpp v182, v182, v182 quad_perm:[2,3,0,1] row_mask:0xf bank_mask:0xf
    v_max_f32_dpp v183, v183, v183 quad_perm:[2,3,0,1] row_mask:0xf bank_mask:0xf
    s_nop 1
    v_max_f32_dpp v180, v180, v180 row_half_mirror row_mask:0xf bank_mask:0xf
    v_max_f32_dpp v181, v181, v181 row_half_mirror row_mask:0xf bank_mask:0xf
    v_max_f32_dpp v182, v182, v182 row_half_mirror row_mask:0xf bank_mask:0xf
    v_max_f32_dpp v183, v183, v183 row_half_mirror row_mask:0xf bank_mask:0xf
    s_nop 1
    v_max_f32_dpp v180, v180, v180 row_mirror row_mask:0xf bank_mask:0xf
    v_max_f32_dpp v181, v181, v181 row_mirror row_mask:0xf bank_mask:0xf
    v_max_f32_dpp v182, v182, v182 row_mirror row_mask:0xf bank_mask:0xf
    v_max_f32_dpp v183, v183, v183 row_mirror row_mask:0xf bank_mask:0xf
    s_nop 1
    v_readlane_b32 s32, v180, 0
    v_readlane_b32 s33, v180, 16
    v_readlane_b32 s34, v180, 32
    v_readlane_b32 s35, v180, 48
    v_readlane_b32 s36, v181, 0
    v_readlane_b32 s37, v181, 16
    v_readlane_b32 s38, v181, 32
    v_readlane_b32 s39, v181, 48
    v_readlane_b32 s40, v182, 0
    v_readlane_b32 s41, v182, 16
    v_readlane_b32 s42, v182, 32
    v_readlane_b32 s43, v182, 48
    v_readlane_b32 s44, v183, 0
    v_readlane_b32 s45, v183, 16
    v_readlane_b32 s46, v183, 32
    v_readlane_b32 s47, v183, 48
    s_nop 1
    v_mov_b32 v180, s32
    v_mov_b32 v181, s36
    v_mov_b32 v182, s40
    v_mov_b32 v183, s44
    v_max_f32 v180, s33, v180
    v_max_f32 v181, s37, v181
    v_max_f32 v182, s41, v182
    v_max_f32 v183, s45, v183
    v_max_f32 v180, s34, v180
    v_max_f32 v181, s38, v181
    v_max_f32 v182, s42, v182
    v_max_f32 v183, s46, v183
    v_max_f32 v180, s35, v180
    v_max_f32 v181, s39, v181
    v_max_f32 v182, s43, v182
    v_max_f32 v183, s47, v183
    v_sub_f32 v184, v176, v180
    v_sub_f32 v185, v177, v181
    v_sub_f32 v186, v178, v182
    v_sub_f32 v187, v179, v183
    v_exp_f32 v184, v184
    v_exp_f32 v185, v185
    v_exp_f32 v186, v186
    v_exp_f32 v187, v187
    v_lshlrev_b32 v8, 10, v1
    v_lshl_add_u32 v9, v2, 4, v8
    s_nop 0
    ds_write_b128 v9, v[184:187] offset:1024
    v_mov_b32 v188, v184
    v_mov_b32 v189, v185
    v_mov_b32 v190, v186
    v_mov_b32 v191, v187
    s_nop 1
    v_add_f32_dpp v188, v188, v188 quad_perm:[1,0,3,2] row_mask:0xf bank_mask:0xf
    v_add_f32_dpp v189, v189, v189 quad_perm:[1,0,3,2] row_mask:0xf bank_mask:0xf
    v_add_f32_dpp v190, v190, v190 quad_perm:[1,0,3,2] row_mask:0xf bank_mask:0xf
    v_add_f32_dpp v191, v191, v191 quad_perm:[1,0,3,2] row_mask:0xf bank_mask:0xf
    s_nop 1
    v_add_f32_dpp v188, v188, v188 quad_perm:[2,3,0,1] row_mask:0xf bank_mask:0xf
    v_add_f32_dpp v189, v189, v189 quad_perm:[2,3,0,1] row_mask:0xf bank_mask:0xf
    v_add_f32_dpp v190, v190, v190 quad_perm:[2,3,0,1] row_mask:0xf bank_mask:0xf
    v_add_f32_dpp v191, v191, v191 quad_perm:[2,3,0,1] row_mask:0xf bank_mask:0xf
    s_nop 1
    v_add_f32_dpp v188, v188, v188 row_half_mirror row_mask:0xf bank_mask:0xf
    v_add_f32_dpp v189, v189, v189 row_half_mirror row_mask:0xf bank_mask:0xf
    v_add_f32_dpp v190, v190, v190 row_half_mirror row_mask:0xf bank_mask:0xf
    v_add_f32_dpp v191, v191, v191 row_half_mirror row_mask:0xf bank_mask:0xf
    s_nop 1
    v_add_f32_dpp v188, v188, v188 row_mirror row_mask:0xf bank_mask:0xf
    v_add_f32_dpp v189, v189, v189 row_mirror row_mask:0xf bank_mask:0xf
    v_add_f32_dpp v190, v190, v190 row_mirror row_mask:0xf bank_mask:0xf
    v_add_f32_dpp v191, v191, v191 row_mirror row_mask:0xf bank_mask:0xf
    s_nop 1
    v_readlane_b32 s32, v188, 0
    v_readlane_b32 s33, v188, 16
    v_readlane_b32 s34, v188, 32
    v_readlane_b32 s35, v188, 48
    v_readlane_b32 s36, v189, 0
    v_readlane_b32 s37, v189, 16
    v_readlane_b32 s38, v189, 32
    v_readlane_b32 s39, v189, 48
    v_readlane_b32 s40, v190, 0
    v_readlane_b32 s41, v190, 16
    v_readlane_b32 s42, v190, 32
    v_readlane_b32 s43, v190, 48
    v_readlane_b32 s44, v191, 0
    v_readlane_b32 s45, v191, 16
    v_readlane_b32 s46, v191, 32
    v_readlane_b32 s47, v191, 48
    s_nop 1
    v_mov_b32 v188, s32
    v_mov_b32 v189, s36
    v_mov_b32 v190, s40
    v_mov_b32 v191, s44
    v_add_f32 v188, s33, v188
    v_add_f32 v189, s37, v189
    v_add_f32 v190, s41, v190
    v_add_f32 v191, s45, v191
    v_add_f32 v188, s34, v188
    v_add_f32 v189, s38, v189
    v_add_f32 v190, s42, v190
    v_add_f32 v191, s46, v191
    v_add_f32 v188, s35, v188
    v_add_f32 v189, s39, v189
    v_add_f32 v190, s43, v190
    v_add_f32 v191, s47, v191
    v_lshl_add_u32 v9, v6, 4, v8
    s_waitcnt lgkmcnt(0)
    ds_read_b128 v[32:35], v9 offset:1024
    ds_read_b128 v[36:39], v9 offset:1088
    ds_read_b128 v[40:43], v9 offset:1152
    ds_read_b128 v[44:47], v9 offset:1216
    ds_read_b128 v[48:51], v9 offset:1280
    ds_read_b128 v[52:55], v9 offset:1344
    ds_read_b128 v[56:59], v9 offset:1408
    ds_read_b128 v[60:63], v9 offset:1472
    ds_read_b128 v[64:67], v9 offset:1536
    ds_read_b128 v[68:71], v9 offset:1600
    ds_read_b128 v[72:75], v9 offset:1664
    ds_read_b128 v[76:79], v9 offset:1728
    ds_read_b128 v[80:83], v9 offset:1792
    ds_read_b128 v[84:87], v9 offset:1856
    ds_read_b128 v[88:91], v9 offset:1920
    ds_read_b128 v[92:95], v9 offset:1984
    v_mov_b32 v192, 0
    v_mov_b32 v193, 0
    v_mov_b32 v194, 0
    v_mov_b32 v195, 0
    v_mov_b32 v196, 0
    v_mov_b32 v197, 0
    v_mov_b32 v198, 0
    v_mov_b32 v199, 0
    v_mov_b32 v200, 0
    v_mov_b32 v201, 0
    v_mov_b32 v202, 0
    v_mov_b32 v203, 0
    v_mov_b32 v204, 0
    v_mov_b32 v205, 0
    v_mov_b32 v206, 0
    v_mov_b32 v207, 0
    v_mov_b32 v208, 0
    v_mov_b32 v209, 0
    v_mov_b32 v210, 0
    v_mov_b32 v211, 0
    v_mov_b32 v212, 0
    v_mov_b32 v213, 0
    v_mov_b32 v214, 0
    v_mov_b32 v215, 0
    v_mov_b32 v216, 0
    v_mov_b32 v217, 0
    v_mov_b32 v218, 0
    v_mov_b32 v219, 0
    v_mov_b32 v220, 0
    v_mov_b32 v221, 0
    v_mov_b32 v222, 0
    v_mov_b32 v223, 0
    s_waitcnt vmcnt(15) lgkmcnt(15)
    v_lshlrev_b32 v224, 16, v96
    v_and_b32 v225, 0xffff0000, v96
    v_lshlrev_b32 v226, 16, v97
    v_and_b32 v227, 0xffff0000, v97
    v_lshlrev_b32 v228, 16, v98
    v_and_b32 v229, 0xffff0000, v98
    v_lshlrev_b32 v230, 16, v99
    v_and_b32 v231, 0xffff0000, v99
    v_pk_fma_f32 v[192:193], v[224:225], v[32:33], v[192:193] op_sel:[0,0,0] op_sel_hi:[1,0,1]
    v_pk_fma_f32 v[194:195], v[226:227], v[32:33], v[194:195] op_sel:[0,0,0] op_sel_hi:[1,0,1]
    v_pk_fma_f32 v[196:197], v[228:229], v[32:33], v[196:197] op_sel:[0,0,0] op_sel_hi:[1,0,1]
    v_pk_fma_f32 v[198:199], v[230:231], v[32:33], v[198:199] op_sel:[0,0,0] op_sel_hi:[1,0,1]
    v_pk_fma_f32 v[200:201], v[224:225], v[32:33], v[200:201] op_sel:[0,1,0] op_sel_hi:[1,1,1]
    v_pk_fma_f32 v[202:203], v[226:227], v[32:33], v[202:203] op_sel:[0,1,0] op_sel_hi:[1,1,1]
    v_pk_fma_f32 v[204:205], v[228:229], v[32:33], v[204:205] op_sel:[0,1,0] op_sel_hi:[1,1,1]
    v_pk_fma_f32 v[206:207], v[230:231], v[32:33], v[206:207] op_sel:[0,1,0] op_sel_hi:[1,1,1]
    v_pk_fma_f32 v[208:209], v[224:225], v[34:35], v[208:209] op_sel:[0,0,0] op_sel_hi:[1,0,1]
    v_pk_fma_f32 v[210:211], v[226:227], v[34:35], v[210:211] op_sel:[0,0,0] op_sel_hi:[1,0,1]
    v_pk_fma_f32 v[212:213], v[228:229], v[34:35], v[212:213] op_sel:[0,0,0] op_sel_hi:[1,0,1]
    v_pk_fma_f32 v[214:215], v[230:231], v[34:35], v[214:215] op_sel:[0,0,0] op_sel_hi:[1,0,1]
    v_pk_fma_f32 v[216:217], v[224:225], v[34:35], v[216:217] op_sel:[0,1,0] op_sel_hi:[1,1,1]
    v_pk_fma_f32 v[218:219], v[226:227], v[34:35], v[218:219] op_sel:[0,1,0] op_sel_hi:[1,1,1]
    v_pk_fma_f32 v[220:221], v[228:229], v[34:35], v[220:221] op_sel:[0,1,0] op_sel_hi:[1,1,1]
    v_pk_fma_f32 v[222:223], v[230:231], v[34:35], v[222:223] op_sel:[0,1,0] op_sel_hi:[1,1,1]
    s_waitcnt vmcnt(14) lgkmcnt(14)
    v_lshlrev_b32 v224, 16, v100
    v_and_b32 v225, 0xffff0000, v100
    v_lshlrev_b32 v226, 16, v101
    v_and_b32 v227, 0xffff0000, v101
    v_lshlrev_b32 v228, 16, v102
    v_and_b32 v229, 0xffff0000, v102
    v_lshlrev_b32 v230, 16, v103
    v_and_b32 v231, 0xffff0000, v103
    v_pk_fma_f32 v[192:193], v[224:225], v[36:37], v[192:193] op_sel:[0,0,0] op_sel_hi:[1,0,1]
    v_pk_fma_f32 v[194:195], v[226:227], v[36:37], v[194:195] op_sel:[0,0,0] op_sel_hi:[1,0,1]
    v_pk_fma_f32 v[196:197], v[228:229], v[36:37], v[196:197] op_sel:[0,0,0] op_sel_hi:[1,0,1]
    v_pk_fma_f32 v[198:199], v[230:231], v[36:37], v[198:199] op_sel:[0,0,0] op_sel_hi:[1,0,1]
    v_pk_fma_f32 v[200:201], v[224:225], v[36:37], v[200:201] op_sel:[0,1,0] op_sel_hi:[1,1,1]
    v_pk_fma_f32 v[202:203], v[226:227], v[36:37], v[202:203] op_sel:[0,1,0] op_sel_hi:[1,1,1]
    v_pk_fma_f32 v[204:205], v[228:229], v[36:37], v[204:205] op_sel:[0,1,0] op_sel_hi:[1,1,1]
    v_pk_fma_f32 v[206:207], v[230:231], v[36:37], v[206:207] op_sel:[0,1,0] op_sel_hi:[1,1,1]
    v_pk_fma_f32 v[208:209], v[224:225], v[38:39], v[208:209] op_sel:[0,0,0] op_sel_hi:[1,0,1]
    v_pk_fma_f32 v[210:211], v[226:227], v[38:39], v[210:211] op_sel:[0,0,0] op_sel_hi:[1,0,1]
    v_pk_fma_f32 v[212:213], v[228:229], v[38:39], v[212:213] op_sel:[0,0,0] op_sel_hi:[1,0,1]
    v_pk_fma_f32 v[214:215], v[230:231], v[38:39], v[214:215] op_sel:[0,0,0] op_sel_hi:[1,0,1]
    v_pk_fma_f32 v[216:217], v[224:225], v[38:39], v[216:217] op_sel:[0,1,0] op_sel_hi:[1,1,1]
    v_pk_fma_f32 v[218:219], v[226:227], v[38:39], v[218:219] op_sel:[0,1,0] op_sel_hi:[1,1,1]
    v_pk_fma_f32 v[220:221], v[228:229], v[38:39], v[220:221] op_sel:[0,1,0] op_sel_hi:[1,1,1]
    v_pk_fma_f32 v[222:223], v[230:231], v[38:39], v[222:223] op_sel:[0,1,0] op_sel_hi:[1,1,1]
    s_waitcnt vmcnt(13) lgkmcnt(13)
    v_lshlrev_b32 v224, 16, v104
    v_and_b32 v225, 0xffff0000, v104
    v_lshlrev_b32 v226, 16, v105
    v_and_b32 v227, 0xffff0000, v105
    v_lshlrev_b32 v228, 16, v106
    v_and_b32 v229, 0xffff0000, v106
    v_lshlrev_b32 v230, 16, v107
    v_and_b32 v231, 0xffff0000, v107
    v_pk_fma_f32 v[192:193], v[224:225], v[40:41], v[192:193] op_sel:[0,0,0] op_sel_hi:[1,0,1]
    v_pk_fma_f32 v[194:195], v[226:227], v[40:41], v[194:195] op_sel:[0,0,0] op_sel_hi:[1,0,1]
    v_pk_fma_f32 v[196:197], v[228:229], v[40:41], v[196:197] op_sel:[0,0,0] op_sel_hi:[1,0,1]
    v_pk_fma_f32 v[198:199], v[230:231], v[40:41], v[198:199] op_sel:[0,0,0] op_sel_hi:[1,0,1]
    v_pk_fma_f32 v[200:201], v[224:225], v[40:41], v[200:201] op_sel:[0,1,0] op_sel_hi:[1,1,1]
    v_pk_fma_f32 v[202:203], v[226:227], v[40:41], v[202:203] op_sel:[0,1,0] op_sel_hi:[1,1,1]
    v_pk_fma_f32 v[204:205], v[228:229], v[40:41], v[204:205] op_sel:[0,1,0] op_sel_hi:[1,1,1]
    v_pk_fma_f32 v[206:207], v[230:231], v[40:41], v[206:207] op_sel:[0,1,0] op_sel_hi:[1,1,1]
    v_pk_fma_f32 v[208:209], v[224:225], v[42:43], v[208:209] op_sel:[0,0,0] op_sel_hi:[1,0,1]
    v_pk_fma_f32 v[210:211], v[226:227], v[42:43], v[210:211] op_sel:[0,0,0] op_sel_hi:[1,0,1]
    v_pk_fma_f32 v[212:213], v[228:229], v[42:43], v[212:213] op_sel:[0,0,0] op_sel_hi:[1,0,1]
    v_pk_fma_f32 v[214:215], v[230:231], v[42:43], v[214:215] op_sel:[0,0,0] op_sel_hi:[1,0,1]
    v_pk_fma_f32 v[216:217], v[224:225], v[42:43], v[216:217] op_sel:[0,1,0] op_sel_hi:[1,1,1]
    v_pk_fma_f32 v[218:219], v[226:227], v[42:43], v[218:219] op_sel:[0,1,0] op_sel_hi:[1,1,1]
    v_pk_fma_f32 v[220:221], v[228:229], v[42:43], v[220:221] op_sel:[0,1,0] op_sel_hi:[1,1,1]
    v_pk_fma_f32 v[222:223], v[230:231], v[42:43], v[222:223] op_sel:[0,1,0] op_sel_hi:[1,1,1]
    s_waitcnt vmcnt(12) lgkmcnt(12)
    v_lshlrev_b32 v224, 16, v108
    v_and_b32 v225, 0xffff0000, v108
    v_lshlrev_b32 v226, 16, v109
    v_and_b32 v227, 0xffff0000, v109
    v_lshlrev_b32 v228, 16, v110
    v_and_b32 v229, 0xffff0000, v110
    v_lshlrev_b32 v230, 16, v111
    v_and_b32 v231, 0xffff0000, v111
    v_pk_fma_f32 v[192:193], v[224:225], v[44:45], v[192:193] op_sel:[0,0,0] op_sel_hi:[1,0,1]
    v_pk_fma_f32 v[194:195], v[226:227], v[44:45], v[194:195] op_sel:[0,0,0] op_sel_hi:[1,0,1]
    v_pk_fma_f32 v[196:197], v[228:229], v[44:45], v[196:197] op_sel:[0,0,0] op_sel_hi:[1,0,1]
    v_pk_fma_f32 v[198:199], v[230:231], v[44:45], v[198:199] op_sel:[0,0,0] op_sel_hi:[1,0,1]
    v_pk_fma_f32 v[200:201], v[224:225], v[44:45], v[200:201] op_sel:[0,1,0] op_sel_hi:[1,1,1]
    v_pk_fma_f32 v[202:203], v[226:227], v[44:45], v[202:203] op_sel:[0,1,0] op_sel_hi:[1,1,1]
    v_pk_fma_f32 v[204:205], v[228:229], v[44:45], v[204:205] op_sel:[0,1,0] op_sel_hi:[1,1,1]
    v_pk_fma_f32 v[206:207], v[230:231], v[44:45], v[206:207] op_sel:[0,1,0] op_sel_hi:[1,1,1]
    v_pk_fma_f32 v[208:209], v[224:225], v[46:47], v[208:209] op_sel:[0,0,0] op_sel_hi:[1,0,1]
    v_pk_fma_f32 v[210:211], v[226:227], v[46:47], v[210:211] op_sel:[0,0,0] op_sel_hi:[1,0,1]
    v_pk_fma_f32 v[212:213], v[228:229], v[46:47], v[212:213] op_sel:[0,0,0] op_sel_hi:[1,0,1]
    v_pk_fma_f32 v[214:215], v[230:231], v[46:47], v[214:215] op_sel:[0,0,0] op_sel_hi:[1,0,1]
    v_pk_fma_f32 v[216:217], v[224:225], v[46:47], v[216:217] op_sel:[0,1,0] op_sel_hi:[1,1,1]
    v_pk_fma_f32 v[218:219], v[226:227], v[46:47], v[218:219] op_sel:[0,1,0] op_sel_hi:[1,1,1]
    v_pk_fma_f32 v[220:221], v[228:229], v[46:47], v[220:221] op_sel:[0,1,0] op_sel_hi:[1,1,1]
    v_pk_fma_f32 v[222:223], v[230:231], v[46:47], v[222:223] op_sel:[0,1,0] op_sel_hi:[1,1,1]
    s_waitcnt vmcnt(11) lgkmcnt(11)
    v_lshlrev_b32 v224, 16, v112
    v_and_b32 v225, 0xffff0000, v112
    v_lshlrev_b32 v226, 16, v113
    v_and_b32 v227, 0xffff0000, v113
    v_lshlrev_b32 v228, 16, v114
    v_and_b32 v229, 0xffff0000, v114
    v_lshlrev_b32 v230, 16, v115
    v_and_b32 v231, 0xffff0000, v115
    v_pk_fma_f32 v[192:193], v[224:225], v[48:49], v[192:193] op_sel:[0,0,0] op_sel_hi:[1,0,1]
    v_pk_fma_f32 v[194:195], v[226:227], v[48:49], v[194:195] op_sel:[0,0,0] op_sel_hi:[1,0,1]
    v_pk_fma_f32 v[196:197], v[228:229], v[48:49], v[196:197] op_sel:[0,0,0] op_sel_hi:[1,0,1]
    v_pk_fma_f32 v[198:199], v[230:231], v[48:49], v[198:199] op_sel:[0,0,0] op_sel_hi:[1,0,1]
    v_pk_fma_f32 v[200:201], v[224:225], v[48:49], v[200:201] op_sel:[0,1,0] op_sel_hi:[1,1,1]
    v_pk_fma_f32 v[202:203], v[226:227], v[48:49], v[202:203] op_sel:[0,1,0] op_sel_hi:[1,1,1]
    v_pk_fma_f32 v[204:205], v[228:229], v[48:49], v[204:205] op_sel:[0,1,0] op_sel_hi:[1,1,1]
    v_pk_fma_f32 v[206:207], v[230:231], v[48:49], v[206:207] op_sel:[0,1,0] op_sel_hi:[1,1,1]
    v_pk_fma_f32 v[208:209], v[224:225], v[50:51], v[208:209] op_sel:[0,0,0] op_sel_hi:[1,0,1]
    v_pk_fma_f32 v[210:211], v[226:227], v[50:51], v[210:211] op_sel:[0,0,0] op_sel_hi:[1,0,1]
    v_pk_fma_f32 v[212:213], v[228:229], v[50:51], v[212:213] op_sel:[0,0,0] op_sel_hi:[1,0,1]
    v_pk_fma_f32 v[214:215], v[230:231], v[50:51], v[214:215] op_sel:[0,0,0] op_sel_hi:[1,0,1]
    v_pk_fma_f32 v[216:217], v[224:225], v[50:51], v[216:217] op_sel:[0,1,0] op_sel_hi:[1,1,1]
    v_pk_fma_f32 v[218:219], v[226:227], v[50:51], v[218:219] op_sel:[0,1,0] op_sel_hi:[1,1,1]
    v_pk_fma_f32 v[220:221], v[228:229], v[50:51], v[220:221] op_sel:[0,1,0] op_sel_hi:[1,1,1]
    v_pk_fma_f32 v[222:223], v[230:231], v[50:51], v[222:223] op_sel:[0,1,0] op_sel_hi:[1,1,1]
    s_waitcnt vmcnt(10) lgkmcnt(10)
    v_lshlrev_b32 v224, 16, v116
    v_and_b32 v225, 0xffff0000, v116
    v_lshlrev_b32 v226, 16, v117
    v_and_b32 v227, 0xffff0000, v117
    v_lshlrev_b32 v228, 16, v118
    v_and_b32 v229, 0xffff0000, v118
    v_lshlrev_b32 v230, 16, v119
    v_and_b32 v231, 0xffff0000, v119
    v_pk_fma_f32 v[192:193], v[224:225], v[52:53], v[192:193] op_sel:[0,0,0] op_sel_hi:[1,0,1]
    v_pk_fma_f32 v[194:195], v[226:227], v[52:53], v[194:195] op_sel:[0,0,0] op_sel_hi:[1,0,1]
    v_pk_fma_f32 v[196:197], v[228:229], v[52:53], v[196:197] op_sel:[0,0,0] op_sel_hi:[1,0,1]
    v_pk_fma_f32 v[198:199], v[230:231], v[52:53], v[198:199] op_sel:[0,0,0] op_sel_hi:[1,0,1]
    v_pk_fma_f32 v[200:201], v[224:225], v[52:53], v[200:201] op_sel:[0,1,0] op_sel_hi:[1,1,1]
    v_pk_fma_f32 v[202:203], v[226:227], v[52:53], v[202:203] op_sel:[0,1,0] op_sel_hi:[1,1,1]
    v_pk_fma_f32 v[204:205], v[228:229], v[52:53], v[204:205] op_sel:[0,1,0] op_sel_hi:[1,1,1]
    v_pk_fma_f32 v[206:207], v[230:231], v[52:53], v[206:207] op_sel:[0,1,0] op_sel_hi:[1,1,1]
    v_pk_fma_f32 v[208:209], v[224:225], v[54:55], v[208:209] op_sel:[0,0,0] op_sel_hi:[1,0,1]
    v_pk_fma_f32 v[210:211], v[226:227], v[54:55], v[210:211] op_sel:[0,0,0] op_sel_hi:[1,0,1]
    v_pk_fma_f32 v[212:213], v[228:229], v[54:55], v[212:213] op_sel:[0,0,0] op_sel_hi:[1,0,1]
    v_pk_fma_f32 v[214:215], v[230:231], v[54:55], v[214:215] op_sel:[0,0,0] op_sel_hi:[1,0,1]
    v_pk_fma_f32 v[216:217], v[224:225], v[54:55], v[216:217] op_sel:[0,1,0] op_sel_hi:[1,1,1]
    v_pk_fma_f32 v[218:219], v[226:227], v[54:55], v[218:219] op_sel:[0,1,0] op_sel_hi:[1,1,1]
    v_pk_fma_f32 v[220:221], v[228:229], v[54:55], v[220:221] op_sel:[0,1,0] op_sel_hi:[1,1,1]
    v_pk_fma_f32 v[222:223], v[230:231], v[54:55], v[222:223] op_sel:[0,1,0] op_sel_hi:[1,1,1]
    s_waitcnt vmcnt(9) lgkmcnt(9)
    v_lshlrev_b32 v224, 16, v120
    v_and_b32 v225, 0xffff0000, v120
    v_lshlrev_b32 v226, 16, v121
    v_and_b32 v227, 0xffff0000, v121
    v_lshlrev_b32 v228, 16, v122
    v_and_b32 v229, 0xffff0000, v122
    v_lshlrev_b32 v230, 16, v123
    v_and_b32 v231, 0xffff0000, v123
    v_pk_fma_f32 v[192:193], v[224:225], v[56:57], v[192:193] op_sel:[0,0,0] op_sel_hi:[1,0,1]
    v_pk_fma_f32 v[194:195], v[226:227], v[56:57], v[194:195] op_sel:[0,0,0] op_sel_hi:[1,0,1]
    v_pk_fma_f32 v[196:197], v[228:229], v[56:57], v[196:197] op_sel:[0,0,0] op_sel_hi:[1,0,1]
    v_pk_fma_f32 v[198:199], v[230:231], v[56:57], v[198:199] op_sel:[0,0,0] op_sel_hi:[1,0,1]
    v_pk_fma_f32 v[200:201], v[224:225], v[56:57], v[200:201] op_sel:[0,1,0] op_sel_hi:[1,1,1]
    v_pk_fma_f32 v[202:203], v[226:227], v[56:57], v[202:203] op_sel:[0,1,0] op_sel_hi:[1,1,1]
    v_pk_fma_f32 v[204:205], v[228:229], v[56:57], v[204:205] op_sel:[0,1,0] op_sel_hi:[1,1,1]
    v_pk_fma_f32 v[206:207], v[230:231], v[56:57], v[206:207] op_sel:[0,1,0] op_sel_hi:[1,1,1]
    v_pk_fma_f32 v[208:209], v[224:225], v[58:59], v[208:209] op_sel:[0,0,0] op_sel_hi:[1,0,1]
    v_pk_fma_f32 v[210:211], v[226:227], v[58:59], v[210:211] op_sel:[0,0,0] op_sel_hi:[1,0,1]
    v_pk_fma_f32 v[212:213], v[228:229], v[58:59], v[212:213] op_sel:[0,0,0] op_sel_hi:[1,0,1]
    v_pk_fma_f32 v[214:215], v[230:231], v[58:59], v[214:215] op_sel:[0,0,0] op_sel_hi:[1,0,1]
    v_pk_fma_f32 v[216:217], v[224:225], v[58:59], v[216:217] op_sel:[0,1,0] op_sel_hi:[1,1,1]
    v_pk_fma_f32 v[218:219], v[226:227], v[58:59], v[218:219] op_sel:[0,1,0] op_sel_hi:[1,1,1]
    v_pk_fma_f32 v[220:221], v[228:229], v[58:59], v[220:221] op_sel:[0,1,0] op_sel_hi:[1,1,1]
    v_pk_fma_f32 v[222:223], v[230:231], v[58:59], v[222:223] op_sel:[0,1,0] op_sel_hi:[1,1,1]
    s_waitcnt vmcnt(8) lgkmcnt(8)
    v_lshlrev_b32 v224, 16, v124
    v_and_b32 v225, 0xffff0000, v124
    v_lshlrev_b32 v226, 16, v125
    v_and_b32 v227, 0xffff0000, v125
    v_lshlrev_b32 v228, 16, v126
    v_and_b32 v229, 0xffff0000, v126
    v_lshlrev_b32 v230, 16, v127
    v_and_b32 v231, 0xffff0000, v127
    v_pk_fma_f32 v[192:193], v[224:225], v[60:61], v[192:193] op_sel:[0,0,0] op_sel_hi:[1,0,1]
    v_pk_fma_f32 v[194:195], v[226:227], v[60:61], v[194:195] op_sel:[0,0,0] op_sel_hi:[1,0,1]
    v_pk_fma_f32 v[196:197], v[228:229], v[60:61], v[196:197] op_sel:[0,0,0] op_sel_hi:[1,0,1]
    v_pk_fma_f32 v[198:199], v[230:231], v[60:61], v[198:199] op_sel:[0,0,0] op_sel_hi:[1,0,1]
    v_pk_fma_f32 v[200:201], v[224:225], v[60:61], v[200:201] op_sel:[0,1,0] op_sel_hi:[1,1,1]
    v_pk_fma_f32 v[202:203], v[226:227], v[60:61], v[202:203] op_sel:[0,1,0] op_sel_hi:[1,1,1]
    v_pk_fma_f32 v[204:205], v[228:229], v[60:61], v[204:205] op_sel:[0,1,0] op_sel_hi:[1,1,1]
    v_pk_fma_f32 v[206:207], v[230:231], v[60:61], v[206:207] op_sel:[0,1,0] op_sel_hi:[1,1,1]
    v_pk_fma_f32 v[208:209], v[224:225], v[62:63], v[208:209] op_sel:[0,0,0] op_sel_hi:[1,0,1]
    v_pk_fma_f32 v[210:211], v[226:227], v[62:63], v[210:211] op_sel:[0,0,0] op_sel_hi:[1,0,1]
    v_pk_fma_f32 v[212:213], v[228:229], v[62:63], v[212:213] op_sel:[0,0,0] op_sel_hi:[1,0,1]
    v_pk_fma_f32 v[214:215], v[230:231], v[62:63], v[214:215] op_sel:[0,0,0] op_sel_hi:[1,0,1]
    v_pk_fma_f32 v[216:217], v[224:225], v[62:63], v[216:217] op_sel:[0,1,0] op_sel_hi:[1,1,1]
    v_pk_fma_f32 v[218:219], v[226:227], v[62:63], v[218:219] op_sel:[0,1,0] op_sel_hi:[1,1,1]
    v_pk_fma_f32 v[220:221], v[228:229], v[62:63], v[220:221] op_sel:[0,1,0] op_sel_hi:[1,1,1]
    v_pk_fma_f32 v[222:223], v[230:231], v[62:63], v[222:223] op_sel:[0,1,0] op_sel_hi:[1,1,1]
    s_waitcnt vmcnt(7) lgkmcnt(7)
    v_lshlrev_b32 v224, 16, v128
    v_and_b32 v225, 0xffff0000, v128
    v_lshlrev_b32 v226, 16, v129
    v_and_b32 v227, 0xffff0000, v129
    v_lshlrev_b32 v228, 16, v130
    v_and_b32 v229, 0xffff0000, v130
    v_lshlrev_b32 v230, 16, v131
    v_and_b32 v231, 0xffff0000, v131
    v_pk_fma_f32 v[192:193], v[224:225], v[64:65], v[192:193] op_sel:[0,0,0] op_sel_hi:[1,0,1]
    v_pk_fma_f32 v[194:195], v[226:227], v[64:65], v[194:195] op_sel:[0,0,0] op_sel_hi:[1,0,1]
    v_pk_fma_f32 v[196:197], v[228:229], v[64:65], v[196:197] op_sel:[0,0,0] op_sel_hi:[1,0,1]
    v_pk_fma_f32 v[198:199], v[230:231], v[64:65], v[198:199] op_sel:[0,0,0] op_sel_hi:[1,0,1]
    v_pk_fma_f32 v[200:201], v[224:225], v[64:65], v[200:201] op_sel:[0,1,0] op_sel_hi:[1,1,1]
    v_pk_fma_f32 v[202:203], v[226:227], v[64:65], v[202:203] op_sel:[0,1,0] op_sel_hi:[1,1,1]
    v_pk_fma_f32 v[204:205], v[228:229], v[64:65], v[204:205] op_sel:[0,1,0] op_sel_hi:[1,1,1]
    v_pk_fma_f32 v[206:207], v[230:231], v[64:65], v[206:207] op_sel:[0,1,0] op_sel_hi:[1,1,1]
    v_pk_fma_f32 v[208:209], v[224:225], v[66:67], v[208:209] op_sel:[0,0,0] op_sel_hi:[1,0,1]
    v_pk_fma_f32 v[210:211], v[226:227], v[66:67], v[210:211] op_sel:[0,0,0] op_sel_hi:[1,0,1]
    v_pk_fma_f32 v[212:213], v[228:229], v[66:67], v[212:213] op_sel:[0,0,0] op_sel_hi:[1,0,1]
    v_pk_fma_f32 v[214:215], v[230:231], v[66:67], v[214:215] op_sel:[0,0,0] op_sel_hi:[1,0,1]
    v_pk_fma_f32 v[216:217], v[224:225], v[66:67], v[216:217] op_sel:[0,1,0] op_sel_hi:[1,1,1]
    v_pk_fma_f32 v[218:219], v[226:227], v[66:67], v[218:219] op_sel:[0,1,0] op_sel_hi:[1,1,1]
    v_pk_fma_f32 v[220:221], v[228:229], v[66:67], v[220:221] op_sel:[0,1,0] op_sel_hi:[1,1,1]
    v_pk_fma_f32 v[222:223], v[230:231], v[66:67], v[222:223] op_sel:[0,1,0] op_sel_hi:[1,1,1]
    s_waitcnt vmcnt(6) lgkmcnt(6)
    v_lshlrev_b32 v224, 16, v132
    v_and_b32 v225, 0xffff0000, v132
    v_lshlrev_b32 v226, 16, v133
    v_and_b32 v227, 0xffff0000, v133
    v_lshlrev_b32 v228, 16, v134
    v_and_b32 v229, 0xffff0000, v134
    v_lshlrev_b32 v230, 16, v135
    v_and_b32 v231, 0xffff0000, v135
    v_pk_fma_f32 v[192:193], v[224:225], v[68:69], v[192:193] op_sel:[0,0,0] op_sel_hi:[1,0,1]
    v_pk_fma_f32 v[194:195], v[226:227], v[68:69], v[194:195] op_sel:[0,0,0] op_sel_hi:[1,0,1]
    v_pk_fma_f32 v[196:197], v[228:229], v[68:69], v[196:197] op_sel:[0,0,0] op_sel_hi:[1,0,1]
    v_pk_fma_f32 v[198:199], v[230:231], v[68:69], v[198:199] op_sel:[0,0,0] op_sel_hi:[1,0,1]
    v_pk_fma_f32 v[200:201], v[224:225], v[68:69], v[200:201] op_sel:[0,1,0] op_sel_hi:[1,1,1]
    v_pk_fma_f32 v[202:203], v[226:227], v[68:69], v[202:203] op_sel:[0,1,0] op_sel_hi:[1,1,1]
    v_pk_fma_f32 v[204:205], v[228:229], v[68:69], v[204:205] op_sel:[0,1,0] op_sel_hi:[1,1,1]
    v_pk_fma_f32 v[206:207], v[230:231], v[68:69], v[206:207] op_sel:[0,1,0] op_sel_hi:[1,1,1]
    v_pk_fma_f32 v[208:209], v[224:225], v[70:71], v[208:209] op_sel:[0,0,0] op_sel_hi:[1,0,1]
    v_pk_fma_f32 v[210:211], v[226:227], v[70:71], v[210:211] op_sel:[0,0,0] op_sel_hi:[1,0,1]
    v_pk_fma_f32 v[212:213], v[228:229], v[70:71], v[212:213] op_sel:[0,0,0] op_sel_hi:[1,0,1]
    v_pk_fma_f32 v[214:215], v[230:231], v[70:71], v[214:215] op_sel:[0,0,0] op_sel_hi:[1,0,1]
    v_pk_fma_f32 v[216:217], v[224:225], v[70:71], v[216:217] op_sel:[0,1,0] op_sel_hi:[1,1,1]
    v_pk_fma_f32 v[218:219], v[226:227], v[70:71], v[218:219] op_sel:[0,1,0] op_sel_hi:[1,1,1]
    v_pk_fma_f32 v[220:221], v[228:229], v[70:71], v[220:221] op_sel:[0,1,0] op_sel_hi:[1,1,1]
    v_pk_fma_f32 v[222:223], v[230:231], v[70:71], v[222:223] op_sel:[0,1,0] op_sel_hi:[1,1,1]
    s_waitcnt vmcnt(5) lgkmcnt(5)
    v_lshlrev_b32 v224, 16, v136
    v_and_b32 v225, 0xffff0000, v136
    v_lshlrev_b32 v226, 16, v137
    v_and_b32 v227, 0xffff0000, v137
    v_lshlrev_b32 v228, 16, v138
    v_and_b32 v229, 0xffff0000, v138
    v_lshlrev_b32 v230, 16, v139
    v_and_b32 v231, 0xffff0000, v139
    v_pk_fma_f32 v[192:193], v[224:225], v[72:73], v[192:193] op_sel:[0,0,0] op_sel_hi:[1,0,1]
    v_pk_fma_f32 v[194:195], v[226:227], v[72:73], v[194:195] op_sel:[0,0,0] op_sel_hi:[1,0,1]
    v_pk_fma_f32 v[196:197], v[228:229], v[72:73], v[196:197] op_sel:[0,0,0] op_sel_hi:[1,0,1]
    v_pk_fma_f32 v[198:199], v[230:231], v[72:73], v[198:199] op_sel:[0,0,0] op_sel_hi:[1,0,1]
    v_pk_fma_f32 v[200:201], v[224:225], v[72:73], v[200:201] op_sel:[0,1,0] op_sel_hi:[1,1,1]
    v_pk_fma_f32 v[202:203], v[226:227], v[72:73], v[202:203] op_sel:[0,1,0] op_sel_hi:[1,1,1]
    v_pk_fma_f32 v[204:205], v[228:229], v[72:73], v[204:205] op_sel:[0,1,0] op_sel_hi:[1,1,1]
    v_pk_fma_f32 v[206:207], v[230:231], v[72:73], v[206:207] op_sel:[0,1,0] op_sel_hi:[1,1,1]
    v_pk_fma_f32 v[208:209], v[224:225], v[74:75], v[208:209] op_sel:[0,0,0] op_sel_hi:[1,0,1]
    v_pk_fma_f32 v[210:211], v[226:227], v[74:75], v[210:211] op_sel:[0,0,0] op_sel_hi:[1,0,1]
    v_pk_fma_f32 v[212:213], v[228:229], v[74:75], v[212:213] op_sel:[0,0,0] op_sel_hi:[1,0,1]
    v_pk_fma_f32 v[214:215], v[230:231], v[74:75], v[214:215] op_sel:[0,0,0] op_sel_hi:[1,0,1]
    v_pk_fma_f32 v[216:217], v[224:225], v[74:75], v[216:217] op_sel:[0,1,0] op_sel_hi:[1,1,1]
    v_pk_fma_f32 v[218:219], v[226:227], v[74:75], v[218:219] op_sel:[0,1,0] op_sel_hi:[1,1,1]
    v_pk_fma_f32 v[220:221], v[228:229], v[74:75], v[220:221] op_sel:[0,1,0] op_sel_hi:[1,1,1]
    v_pk_fma_f32 v[222:223], v[230:231], v[74:75], v[222:223] op_sel:[0,1,0] op_sel_hi:[1,1,1]
    s_waitcnt vmcnt(4) lgkmcnt(4)
    v_lshlrev_b32 v224, 16, v140
    v_and_b32 v225, 0xffff0000, v140
    v_lshlrev_b32 v226, 16, v141
    v_and_b32 v227, 0xffff0000, v141
    v_lshlrev_b32 v228, 16, v142
    v_and_b32 v229, 0xffff0000, v142
    v_lshlrev_b32 v230, 16, v143
    v_and_b32 v231, 0xffff0000, v143
    v_pk_fma_f32 v[192:193], v[224:225], v[76:77], v[192:193] op_sel:[0,0,0] op_sel_hi:[1,0,1]
    v_pk_fma_f32 v[194:195], v[226:227], v[76:77], v[194:195] op_sel:[0,0,0] op_sel_hi:[1,0,1]
    v_pk_fma_f32 v[196:197], v[228:229], v[76:77], v[196:197] op_sel:[0,0,0] op_sel_hi:[1,0,1]
    v_pk_fma_f32 v[198:199], v[230:231], v[76:77], v[198:199] op_sel:[0,0,0] op_sel_hi:[1,0,1]
    v_pk_fma_f32 v[200:201], v[224:225], v[76:77], v[200:201] op_sel:[0,1,0] op_sel_hi:[1,1,1]
    v_pk_fma_f32 v[202:203], v[226:227], v[76:77], v[202:203] op_sel:[0,1,0] op_sel_hi:[1,1,1]
    v_pk_fma_f32 v[204:205], v[228:229], v[76:77], v[204:205] op_sel:[0,1,0] op_sel_hi:[1,1,1]
    v_pk_fma_f32 v[206:207], v[230:231], v[76:77], v[206:207] op_sel:[0,1,0] op_sel_hi:[1,1,1]
    v_pk_fma_f32 v[208:209], v[224:225], v[78:79], v[208:209] op_sel:[0,0,0] op_sel_hi:[1,0,1]
    v_pk_fma_f32 v[210:211], v[226:227], v[78:79], v[210:211] op_sel:[0,0,0] op_sel_hi:[1,0,1]
    v_pk_fma_f32 v[212:213], v[228:229], v[78:79], v[212:213] op_sel:[0,0,0] op_sel_hi:[1,0,1]
    v_pk_fma_f32 v[214:215], v[230:231], v[78:79], v[214:215] op_sel:[0,0,0] op_sel_hi:[1,0,1]
    v_pk_fma_f32 v[216:217], v[224:225], v[78:79], v[216:217] op_sel:[0,1,0] op_sel_hi:[1,1,1]
    v_pk_fma_f32 v[218:219], v[226:227], v[78:79], v[218:219] op_sel:[0,1,0] op_sel_hi:[1,1,1]
    v_pk_fma_f32 v[220:221], v[228:229], v[78:79], v[220:221] op_sel:[0,1,0] op_sel_hi:[1,1,1]
    v_pk_fma_f32 v[222:223], v[230:231], v[78:79], v[222:223] op_sel:[0,1,0] op_sel_hi:[1,1,1]
    s_waitcnt vmcnt(3) lgkmcnt(3)
    v_lshlrev_b32 v224, 16, v144
    v_and_b32 v225, 0xffff0000, v144
    v_lshlrev_b32 v226, 16, v145
    v_and_b32 v227, 0xffff0000, v145
    v_lshlrev_b32 v228, 16, v146
    v_and_b32 v229, 0xffff0000, v146
    v_lshlrev_b32 v230, 16, v147
    v_and_b32 v231, 0xffff0000, v147
    v_pk_fma_f32 v[192:193], v[224:225], v[80:81], v[192:193] op_sel:[0,0,0] op_sel_hi:[1,0,1]
    v_pk_fma_f32 v[194:195], v[226:227], v[80:81], v[194:195] op_sel:[0,0,0] op_sel_hi:[1,0,1]
    v_pk_fma_f32 v[196:197], v[228:229], v[80:81], v[196:197] op_sel:[0,0,0] op_sel_hi:[1,0,1]
    v_pk_fma_f32 v[198:199], v[230:231], v[80:81], v[198:199] op_sel:[0,0,0] op_sel_hi:[1,0,1]
    v_pk_fma_f32 v[200:201], v[224:225], v[80:81], v[200:201] op_sel:[0,1,0] op_sel_hi:[1,1,1]
    v_pk_fma_f32 v[202:203], v[226:227], v[80:81], v[202:203] op_sel:[0,1,0] op_sel_hi:[1,1,1]
    v_pk_fma_f32 v[204:205], v[228:229], v[80:81], v[204:205] op_sel:[0,1,0] op_sel_hi:[1,1,1]
    v_pk_fma_f32 v[206:207], v[230:231], v[80:81], v[206:207] op_sel:[0,1,0] op_sel_hi:[1,1,1]
    v_pk_fma_f32 v[208:209], v[224:225], v[82:83], v[208:209] op_sel:[0,0,0] op_sel_hi:[1,0,1]
    v_pk_fma_f32 v[210:211], v[226:227], v[82:83], v[210:211] op_sel:[0,0,0] op_sel_hi:[1,0,1]
    v_pk_fma_f32 v[212:213], v[228:229], v[82:83], v[212:213] op_sel:[0,0,0] op_sel_hi:[1,0,1]
    v_pk_fma_f32 v[214:215], v[230:231], v[82:83], v[214:215] op_sel:[0,0,0] op_sel_hi:[1,0,1]
    v_pk_fma_f32 v[216:217], v[224:225], v[82:83], v[216:217] op_sel:[0,1,0] op_sel_hi:[1,1,1]
    v_pk_fma_f32 v[218:219], v[226:227], v[82:83], v[218:219] op_sel:[0,1,0] op_sel_hi:[1,1,1]
    v_pk_fma_f32 v[220:221], v[228:229], v[82:83], v[220:221] op_sel:[0,1,0] op_sel_hi:[1,1,1]
    v_pk_fma_f32 v[222:223], v[230:231], v[82:83], v[222:223] op_sel:[0,1,0] op_sel_hi:[1,1,1]
    s_waitcnt vmcnt(2) lgkmcnt(2)
    v_lshlrev_b32 v224, 16, v148
    v_and_b32 v225, 0xffff0000, v148
    v_lshlrev_b32 v226, 16, v149
    v_and_b32 v227, 0xffff0000, v149
    v_lshlrev_b32 v228, 16, v150
    v_and_b32 v229, 0xffff0000, v150
    v_lshlrev_b32 v230, 16, v151
    v_and_b32 v231, 0xffff0000, v151
    v_pk_fma_f32 v[192:193], v[224:225], v[84:85], v[192:193] op_sel:[0,0,0] op_sel_hi:[1,0,1]
    v_pk_fma_f32 v[194:195], v[226:227], v[84:85], v[194:195] op_sel:[0,0,0] op_sel_hi:[1,0,1]
    v_pk_fma_f32 v[196:197], v[228:229], v[84:85], v[196:197] op_sel:[0,0,0] op_sel_hi:[1,0,1]
    v_pk_fma_f32 v[198:199], v[230:231], v[84:85], v[198:199] op_sel:[0,0,0] op_sel_hi:[1,0,1]
    v_pk_fma_f32 v[200:201], v[224:225], v[84:85], v[200:201] op_sel:[0,1,0] op_sel_hi:[1,1,1]
    v_pk_fma_f32 v[202:203], v[226:227], v[84:85], v[202:203] op_sel:[0,1,0] op_sel_hi:[1,1,1]
    v_pk_fma_f32 v[204:205], v[228:229], v[84:85], v[204:205] op_sel:[0,1,0] op_sel_hi:[1,1,1]
    v_pk_fma_f32 v[206:207], v[230:231], v[84:85], v[206:207] op_sel:[0,1,0] op_sel_hi:[1,1,1]
    v_pk_fma_f32 v[208:209], v[224:225], v[86:87], v[208:209] op_sel:[0,0,0] op_sel_hi:[1,0,1]
    v_pk_fma_f32 v[210:211], v[226:227], v[86:87], v[210:211] op_sel:[0,0,0] op_sel_hi:[1,0,1]
    v_pk_fma_f32 v[212:213], v[228:229], v[86:87], v[212:213] op_sel:[0,0,0] op_sel_hi:[1,0,1]
    v_pk_fma_f32 v[214:215], v[230:231], v[86:87], v[214:215] op_sel:[0,0,0] op_sel_hi:[1,0,1]
    v_pk_fma_f32 v[216:217], v[224:225], v[86:87], v[216:217] op_sel:[0,1,0] op_sel_hi:[1,1,1]
    v_pk_fma_f32 v[218:219], v[226:227], v[86:87], v[218:219] op_sel:[0,1,0] op_sel_hi:[1,1,1]
    v_pk_fma_f32 v[220:221], v[228:229], v[86:87], v[220:221] op_sel:[0,1,0] op_sel_hi:[1,1,1]
    v_pk_fma_f32 v[222:223], v[230:231], v[86:87], v[222:223] op_sel:[0,1,0] op_sel_hi:[1,1,1]
    s_waitcnt vmcnt(1) lgkmcnt(1)
    v_lshlrev_b32 v224, 16, v152
    v_and_b32 v225, 0xffff0000, v152
    v_lshlrev_b32 v226, 16, v153
    v_and_b32 v227, 0xffff0000, v153
    v_lshlrev_b32 v228, 16, v154
    v_and_b32 v229, 0xffff0000, v154
    v_lshlrev_b32 v230, 16, v155
    v_and_b32 v231, 0xffff0000, v155
    v_pk_fma_f32 v[192:193], v[224:225], v[88:89], v[192:193] op_sel:[0,0,0] op_sel_hi:[1,0,1]
    v_pk_fma_f32 v[194:195], v[226:227], v[88:89], v[194:195] op_sel:[0,0,0] op_sel_hi:[1,0,1]
    v_pk_fma_f32 v[196:197], v[228:229], v[88:89], v[196:197] op_sel:[0,0,0] op_sel_hi:[1,0,1]
    v_pk_fma_f32 v[198:199], v[230:231], v[88:89], v[198:199] op_sel:[0,0,0] op_sel_hi:[1,0,1]
    v_pk_fma_f32 v[200:201], v[224:225], v[88:89], v[200:201] op_sel:[0,1,0] op_sel_hi:[1,1,1]
    v_pk_fma_f32 v[202:203], v[226:227], v[88:89], v[202:203] op_sel:[0,1,0] op_sel_hi:[1,1,1]
    v_pk_fma_f32 v[204:205], v[228:229], v[88:89], v[204:205] op_sel:[0,1,0] op_sel_hi:[1,1,1]
    v_pk_fma_f32 v[206:207], v[230:231], v[88:89], v[206:207] op_sel:[0,1,0] op_sel_hi:[1,1,1]
    v_pk_fma_f32 v[208:209], v[224:225], v[90:91], v[208:209] op_sel:[0,0,0] op_sel_hi:[1,0,1]
    v_pk_fma_f32 v[210:211], v[226:227], v[90:91], v[210:211] op_sel:[0,0,0] op_sel_hi:[1,0,1]
    v_pk_fma_f32 v[212:213], v[228:229], v[90:91], v[212:213] op_sel:[0,0,0] op_sel_hi:[1,0,1]
    v_pk_fma_f32 v[214:215], v[230:231], v[90:91], v[214:215] op_sel:[0,0,0] op_sel_hi:[1,0,1]
    v_pk_fma_f32 v[216:217], v[224:225], v[90:91], v[216:217] op_sel:[0,1,0] op_sel_hi:[1,1,1]
    v_pk_fma_f32 v[218:219], v[226:227], v[90:91], v[218:219] op_sel:[0,1,0] op_sel_hi:[1,1,1]
    v_pk_fma_f32 v[220:221], v[228:229], v[90:91], v[220:221] op_sel:[0,1,0] op_sel_hi:[1,1,1]
    v_pk_fma_f32 v[222:223], v[230:231], v[90:91], v[222:223] op_sel:[0,1,0] op_sel_hi:[1,1,1]
    s_waitcnt vmcnt(0) lgkmcnt(0)
    v_lshlrev_b32 v224, 16, v156
    v_and_b32 v225, 0xffff0000, v156
    v_lshlrev_b32 v226, 16, v157
    v_and_b32 v227, 0xffff0000, v157
    v_lshlrev_b32 v228, 16, v158
    v_and_b32 v229, 0xffff0000, v158
    v_lshlrev_b32 v230, 16, v159
    v_and_b32 v231, 0xffff0000, v159
    v_pk_fma_f32 v[192:193], v[224:225], v[92:93], v[192:193] op_sel:[0,0,0] op_sel_hi:[1,0,1]
    v_pk_fma_f32 v[194:195], v[226:227], v[92:93], v[194:195] op_sel:[0,0,0] op_sel_hi:[1,0,1]
    v_pk_fma_f32 v[196:197], v[228:229], v[92:93], v[196:197] op_sel:[0,0,0] op_sel_hi:[1,0,1]
    v_pk_fma_f32 v[198:199], v[230:231], v[92:93], v[198:199] op_sel:[0,0,0] op_sel_hi:[1,0,1]
    v_pk_fma_f32 v[200:201], v[224:225], v[92:93], v[200:201] op_sel:[0,1,0] op_sel_hi:[1,1,1]
    v_pk_fma_f32 v[202:203], v[226:227], v[92:93], v[202:203] op_sel:[0,1,0] op_sel_hi:[1,1,1]
    v_pk_fma_f32 v[204:205], v[228:229], v[92:93], v[204:205] op_sel:[0,1,0] op_sel_hi:[1,1,1]
    v_pk_fma_f32 v[206:207], v[230:231], v[92:93], v[206:207] op_sel:[0,1,0] op_sel_hi:[1,1,1]
    v_pk_fma_f32 v[208:209], v[224:225], v[94:95], v[208:209] op_sel:[0,0,0] op_sel_hi:[1,0,1]
    v_pk_fma_f32 v[210:211], v[226:227], v[94:95], v[210:211] op_sel:[0,0,0] op_sel_hi:[1,0,1]
    v_pk_fma_f32 v[212:213], v[228:229], v[94:95], v[212:213] op_sel:[0,0,0] op_sel_hi:[1,0,1]
    v_pk_fma_f32 v[214:215], v[230:231], v[94:95], v[214:215] op_sel:[0,0,0] op_sel_hi:[1,0,1]
    v_pk_fma_f32 v[216:217], v[224:225], v[94:95], v[216:217] op_sel:[0,1,0] op_sel_hi:[1,1,1]
    v_pk_fma_f32 v[218:219], v[226:227], v[94:95], v[218:219] op_sel:[0,1,0] op_sel_hi:[1,1,1]
    v_pk_fma_f32 v[220:221], v[228:229], v[94:95], v[220:221] op_sel:[0,1,0] op_sel_hi:[1,1,1]
    v_pk_fma_f32 v[222:223], v[230:231], v[94:95], v[222:223] op_sel:[0,1,0] op_sel_hi:[1,1,1]
    v_lshlrev_b32 v8, 5, v1
    ds_write_b128 v8, v[180:183] offset:5120
    ds_write_b128 v8, v[188:191] offset:5136
    s_waitcnt lgkmcnt(0)
    s_barrier
    v_mov_b32 v9, 0
    ds_read_b128 v[32:35], v9 offset:5120
    ds_read_b128 v[36:39], v9 offset:5136
    ds_read_b128 v[40:43], v9 offset:5152
    ds_read_b128 v[44:47], v9 offset:5168
    ds_read_b128 v[48:51], v9 offset:5184
    ds_read_b128 v[52:55], v9 offset:5200
    ds_read_b128 v[56:59], v9 offset:5216
    ds_read_b128 v[60:63], v9 offset:5232
    s_waitcnt lgkmcnt(0)
    v_max_f32 v64, v32, v40
    v_max3_f32 v64, v64, v48, v56
    v_max_f32 v65, v33, v41
    v_max3_f32 v65, v65, v49, v57
    v_max_f32 v66, v34, v42
    v_max3_f32 v66, v66, v50, v58
    v_max_f32 v67, v35, v43
    v_max3_f32 v67, v67, v51, v59
    v_sub_f32 v72, v180, v64
    v_sub_f32 v73, v181, v65
    v_sub_f32 v74, v182, v66
    v_sub_f32 v75, v183, v67
    v_exp_f32 v72, v72
    v_exp_f32 v73, v73
    v_exp_f32 v74, v74
    v_exp_f32 v75, v75
    v_sub_f32 v32, v32, v64
    v_sub_f32 v33, v33, v65
    v_sub_f32 v34, v34, v66
    v_sub_f32 v35, v35, v67
    v_exp_f32 v32, v32
    v_exp_f32 v33, v33
    v_exp_f32 v34, v34
    v_exp_f32 v35, v35
    v_sub_f32 v40, v40, v64
    v_sub_f32 v41, v41, v65
    v_sub_f32 v42, v42, v66
    v_sub_f32 v43, v43, v67
    v_exp_f32 v40, v40
    v_exp_f32 v41, v41
    v_exp_f32 v42, v42
    v_exp_f32 v43, v43
    v_sub_f32 v48, v48, v64
    v_sub_f32 v49, v49, v65
    v_sub_f32 v50, v50, v66
    v_sub_f32 v51, v51, v67
    v_exp_f32 v48, v48
    v_exp_f32 v49, v49
    v_exp_f32 v50, v50
    v_exp_f32 v51, v51
    v_sub_f32 v56, v56, v64
    v_sub_f32 v57, v57, v65
    v_sub_f32 v58, v58, v66
    v_sub_f32 v59, v59, v67
    v_exp_f32 v56, v56
    v_exp_f32 v57, v57
    v_exp_f32 v58, v58
    v_exp_f32 v59, v59
    s_nop 0
    v_mul_f32 v68, v32, v36
    v_mul_f32 v69, v33, v37
    v_mul_f32 v70, v34, v38
    v_mul_f32 v71, v35, v39
    v_fmac_f32 v68, v40, v44
    v_fmac_f32 v69, v41, v45
    v_fmac_f32 v70, v42, v46
    v_fmac_f32 v71, v43, v47
    v_fmac_f32 v68, v48, v52
    v_fmac_f32 v69, v49, v53
    v_fmac_f32 v70, v50, v54
    v_fmac_f32 v71, v51, v55
    v_fmac_f32 v68, v56, v60
    v_fmac_f32 v69, v57, v61
    v_fmac_f32 v70, v58, v62
    v_fmac_f32 v71, v59, v63
    v_pk_mul_f32 v[192:193], v[192:193], v[72:73] op_sel:[0,0] op_sel_hi:[1,0]
    v_pk_mul_f32 v[194:195], v[194:195], v[72:73] op_sel:[0,0] op_sel_hi:[1,0]
    v_pk_mul_f32 v[196:197], v[196:197], v[72:73] op_sel:[0,0] op_sel_hi:[1,0]
    v_pk_mul_f32 v[198:199], v[198:199], v[72:73] op_sel:[0,0] op_sel_hi:[1,0]
    v_pk_mul_f32 v[200:201], v[200:201], v[72:73] op_sel:[0,1] op_sel_hi:[1,1]
    v_pk_mul_f32 v[202:203], v[202:203], v[72:73] op_sel:[0,1] op_sel_hi:[1,1]
    v_pk_mul_f32 v[204:205], v[204:205], v[72:73] op_sel:[0,1] op_sel_hi:[1,1]
    v_pk_mul_f32 v[206:207], v[206:207], v[72:73] op_sel:[0,1] op_sel_hi:[1,1]
    v_pk_mul_f32 v[208:209], v[208:209], v[74:75] op_sel:[0,0] op_sel_hi:[1,0]
    v_pk_mul_f32 v[210:211], v[210:211], v[74:75] op_sel:[0,0] op_sel_hi:[1,0]
    v_pk_mul_f32 v[212:213], v[212:213], v[74:75] op_sel:[0,0] op_sel_hi:[1,0]
    v_pk_mul_f32 v[214:215], v[214:215], v[74:75] op_sel:[0,0] op_sel_hi:[1,0]
    v_pk_mul_f32 v[216:217], v[216:217], v[74:75] op_sel:[0,1] op_sel_hi:[1,1]
    v_pk_mul_f32 v[218:219], v[218:219], v[74:75] op_sel:[0,1] op_sel_hi:[1,1]
    v_pk_mul_f32 v[220:221], v[220:221], v[74:75] op_sel:[0,1] op_sel_hi:[1,1]
    v_pk_mul_f32 v[222:223], v[222:223], v[74:75] op_sel:[0,1] op_sel_hi:[1,1]
    v_lshrrev_b32 v8, 4, v0
    v_lshlrev_b32 v8, 11, v8
    v_and_b32 v9, 15, v0
    v_lshl_add_u32 v8, v9, 5, v8
    ds_write_b128 v8, v[192:195] offset:8192
    ds_write_b128 v8, v[196:199] offset:8208
    ds_write_b128 v8, v[200:203] offset:8704
    ds_write_b128 v8, v[204:207] offset:8720
    ds_write_b128 v8, v[208:211] offset:9216
    ds_write_b128 v8, v[212:215] offset:9232
    ds_write_b128 v8, v[216:219] offset:9728
    ds_write_b128 v8, v[220:223] offset:9744
    s_waitcnt lgkmcnt(0)
    s_barrier
    v_lshlrev_b32 v8, 3, v0
    ds_read_b64 v[96:97], v8 offset:8192
    ds_read_b64 v[98:99], v8 offset:10240
    ds_read_b64 v[100:101], v8 offset:12288
    ds_read_b64 v[102:103], v8 offset:14336
    ds_read_b64 v[104:105], v8 offset:16384
    ds_read_b64 v[106:107], v8 offset:18432
    ds_read_b64 v[108:109], v8 offset:20480
    ds_read_b64 v[110:111], v8 offset:22528
    ds_read_b64 v[112:113], v8 offset:24576
    ds_read_b64 v[114:115], v8 offset:26624
    ds_read_b64 v[116:117], v8 offset:28672
    ds_read_b64 v[118:119], v8 offset:30720
    ds_read_b64 v[120:121], v8 offset:32768
    ds_read_b64 v[122:123], v8 offset:34816
    ds_read_b64 v[124:125], v8 offset:36864
    ds_read_b64 v[126:127], v8 offset:38912
    s_waitcnt lgkmcnt(14)
    v_pk_add_f32 v[96:97], v[96:97], v[98:99]
    s_waitcnt lgkmcnt(13)
    v_pk_add_f32 v[96:97], v[96:97], v[100:101]
    s_waitcnt lgkmcnt(12)
    v_pk_add_f32 v[96:97], v[96:97], v[102:103]
    s_waitcnt lgkmcnt(11)
    v_pk_add_f32 v[96:97], v[96:97], v[104:105]
    s_waitcnt lgkmcnt(10)
    v_pk_add_f32 v[96:97], v[96:97], v[106:107]
    s_waitcnt lgkmcnt(9)
    v_pk_add_f32 v[96:97], v[96:97], v[108:109]
    s_waitcnt lgkmcnt(8)
    v_pk_add_f32 v[96:97], v[96:97], v[110:111]
    s_waitcnt lgkmcnt(7)
    v_pk_add_f32 v[96:97], v[96:97], v[112:113]
    s_waitcnt lgkmcnt(6)
    v_pk_add_f32 v[96:97], v[96:97], v[114:115]
    s_waitcnt lgkmcnt(5)
    v_pk_add_f32 v[96:97], v[96:97], v[116:117]
    s_waitcnt lgkmcnt(4)
    v_pk_add_f32 v[96:97], v[96:97], v[118:119]
    s_waitcnt lgkmcnt(3)
    v_pk_add_f32 v[96:97], v[96:97], v[120:121]
    s_waitcnt lgkmcnt(2)
    v_pk_add_f32 v[96:97], v[96:97], v[122:123]
    s_waitcnt lgkmcnt(1)
    v_pk_add_f32 v[96:97], v[96:97], v[124:125]
    s_waitcnt lgkmcnt(0)
    v_pk_add_f32 v[96:97], v[96:97], v[126:127]
    s_lshl_b32 s19, s14, 2
    s_add_u32 s19, s19, s15
    s_lshl_b32 s19, s19, 5
    s_lshl_b32 s20, s16, 2
    s_add_u32 s19, s19, s20
    s_lshl_b32 s21, s19, 12
    s_lshl_b32 s20, s17, 9
    s_add_u32 s21, s21, s20
    s_add_u32 s21, s21, 1048576
    v_lshrrev_b32 v8, 6, v0
    v_lshlrev_b32 v8, 12, v8
    v_and_b32 v9, 63, v0
    v_lshlrev_b32 v9, 3, v9
    v_add3_u32 v8, v8, v9, s21
    global_store_dwordx2 v8, v[96:97], s[12:13]
    s_lshl_b32 s21, s19, 6
    s_lshl_b32 s20, s17, 3
    s_add_u32 s21, s21, s20
    s_add_u32 s21, s21, 2097152
    v_cmp_eq_u32 vcc, 1, v0
    s_nop 1
    v_cndmask_b32 v10, v64, v65, vcc
    v_cndmask_b32 v11, v68, v69, vcc
    v_cmp_eq_u32 vcc, 2, v0
    s_nop 1
    v_cndmask_b32 v10, v10, v66, vcc
    v_cndmask_b32 v11, v11, v70, vcc
    v_cmp_eq_u32 vcc, 3, v0
    s_nop 1
    v_cndmask_b32 v10, v10, v67, vcc
    v_cndmask_b32 v11, v11, v71, vcc
    v_lshlrev_b32 v8, 6, v0
    v_add_u32 v8, s21, v8
    v_cmp_gt_u32 vcc, 4, v0
    s_and_saveexec_b64 s[30:31], vcc
    s_cbranch_execz L_a_end
    global_store_dwordx2 v8, v[10:11], s[12:13]
L_a_end:
    s_endpgm
.globl oproj_kernel
.p2align 8
.type oproj_kernel,@function
oproj_kernel:
    s_cmp_ge_u32 s2, 256
    s_cbranch_scc1 L_o_end
    s_load_dwordx2 s[4:5], s[0:1], 32
    s_load_dwordx2 s[6:7], s[0:1], 72
    s_load_dwordx2 s[8:9], s[0:1], 80
    s_load_dwordx2 s[10:11], s[0:1], 88
    s_load_dwordx2 s[12:13], s[0:1], 96
    s_lshr_b32 s14, s2, 7
    s_lshr_b32 s15, s2, 3
    s_and_b32 s15, s15, 15
    s_and_b32 s16, s2, 7
    v_and_b32 v1, 7, v0
    v_lshrrev_b32 v2, 3, v0
    s_lshl_b32 s17, s15, 8
    v_lshl_add_u32 v3, v2, 3, s17
    v_lshlrev_b32 v3, 10, v3
    s_lshl_b32 s18, s16, 7
    v_lshlrev_b32 v4, 4, v1
    v_add3_u32 v3, v3, s18, v4
    v_add_u32 v4, 4096, v3
    s_waitcnt lgkmcnt(0)
    s_cmp_eq_u32 s14, 0
    s_cselect_b64 s[4:5], s[4:5], s[6:7]
    v_lshrrev_b32 v5, 6, v0
    v_and_b32 v6, 63, v0
    v_lshrrev_b32 v7, 5, v6
    s_lshl_b32 s19, s14, 2
    v_add_u32 v8, s19, v5
    v_lshlrev_b32 v8, 5, v8
    s_lshl_b32 s20, s15, 1
    v_add3_u32 v8, v8, s20, v7
    v_lshlrev_b32 v9, 6, v8
    v_add_u32 v9, 2097152, v9
    v_lshlrev_b32 v10, 12, v8
    v_and_b32 v11, 31, v6
    v_lshl_add_u32 v10, v11, 4, v10
    v_add_u32 v10, 1048576, v10
    global_load_dwordx4 v[16:19], v9, s[12:13] offset:0
    global_load_dwordx4 v[20:23], v9, s[12:13] offset:16
    global_load_dwordx4 v[24:27], v9, s[12:13] offset:32
    global_load_dwordx4 v[28:31], v9, s[12:13] offset:48
    global_load_dwordx4 v[32:35], v10, s[12:13] offset:0
    global_load_dwordx4 v[36:39], v10, s[12:13] offset:512
    global_load_dwordx4 v[40:43], v10, s[12:13] offset:1024
    global_load_dwordx4 v[44:47], v10, s[12:13] offset:1536
    global_load_dwordx4 v[48:51], v10, s[12:13] offset:2048
    global_load_dwordx4 v[52:55], v10, s[12:13] offset:2560
    global_load_dwordx4 v[56:59], v10, s[12:13] offset:3072
    global_load_dwordx4 v[60:63], v10, s[12:13] offset:3584
    global_load_dwordx4 v[64:67], v3, s[4:5] offset:0 nt
    global_load_dwordx4 v[68:71], v3, s[4:5] offset:1024 nt
    global_load_dwordx4 v[72:75], v3, s[4:5] offset:2048 nt
    global_load_dwordx4 v[76:79], v3, s[4:5] offset:3072 nt
    global_load_dwordx4 v[80:83], v4, s[4:5] offset:0 nt
    global_load_dwordx4 v[84:87], v4, s[4:5] offset:1024 nt
    global_load_dwordx4 v[88:91], v4, s[4:5] offset:2048 nt
    global_load_dwordx4 v[92:95], v4, s[4:5] offset:3072 nt
    s_waitcnt vmcnt(8)
    v_max_f32 v12, v16, v18
    v_max3_f32 v12, v12, v20, v22
    v_max3_f32 v12, v12, v24, v26
    v_max3_f32 v12, v12, v28, v30
    v_sub_f32 v16, v16, v12
    v_sub_f32 v18, v18, v12
    v_sub_f32 v20, v20, v12
    v_sub_f32 v22, v22, v12
    v_sub_f32 v24, v24, v12
    v_sub_f32 v26, v26, v12
    v_sub_f32 v28, v28, v12
    v_sub_f32 v30, v30, v12
    v_exp_f32 v16, v16
    v_exp_f32 v18, v18
    v_exp_f32 v20, v20
    v_exp_f32 v22, v22
    v_exp_f32 v24, v24
    v_exp_f32 v26, v26
    v_exp_f32 v28, v28
    v_exp_f32 v30, v30
    s_nop 0
    v_mul_f32 v13, v16, v17
    v_fmac_f32 v13, v18, v19
    v_fmac_f32 v13, v20, v21
    v_fmac_f32 v13, v22, v23
    v_fmac_f32 v13, v24, v25
    v_fmac_f32 v13, v26, v27
    v_fmac_f32 v13, v28, v29
    v_fmac_f32 v13, v30, v31
    v_rcp_f32 v13, v13
    v_mul_f32 v32, v32, v16
    v_mul_f32 v33, v33, v16
    v_mul_f32 v34, v34, v16
    v_mul_f32 v35, v35, v16
    v_fmac_f32 v32, v36, v18
    v_fmac_f32 v33, v37, v18
    v_fmac_f32 v34, v38, v18
    v_fmac_f32 v35, v39, v18
    v_fmac_f32 v32, v40, v20
    v_fmac_f32 v33, v41, v20
    v_fmac_f32 v34, v42, v20
    v_fmac_f32 v35, v43, v20
    v_fmac_f32 v32, v44, v22
    v_fmac_f32 v33, v45, v22
    v_fmac_f32 v34, v46, v22
    v_fmac_f32 v35, v47, v22
    v_fmac_f32 v32, v48, v24
    v_fmac_f32 v33, v49, v24
    v_fmac_f32 v34, v50, v24
    v_fmac_f32 v35, v51, v24
    v_fmac_f32 v32, v52, v26
    v_fmac_f32 v33, v53, v26
    v_fmac_f32 v34, v54, v26
    v_fmac_f32 v35, v55, v26
    v_fmac_f32 v32, v56, v28
    v_fmac_f32 v33, v57, v28
    v_fmac_f32 v34, v58, v28
    v_fmac_f32 v35, v59, v28
    v_fmac_f32 v32, v60, v30
    v_fmac_f32 v33, v61, v30
    v_fmac_f32 v34, v62, v30
    v_fmac_f32 v35, v63, v30
    v_mul_f32 v32, v32, v13
    v_mul_f32 v33, v33, v13
    v_mul_f32 v34, v34, v13
    v_mul_f32 v35, v35, v13
    v_cvt_pk_bf16_f32 v14, v32, v33
    v_cvt_pk_bf16_f32 v15, v34, v35
    v_lshlrev_b32 v32, 16, v14
    v_and_b32 v33, 0xffff0000, v14
    v_lshlrev_b32 v34, 16, v15
    v_and_b32 v35, 0xffff0000, v15
    v_lshlrev_b32 v11, 4, v0
    ds_write_b128 v11, v[32:35]
    s_waitcnt lgkmcnt(0)
    s_barrier
    v_lshlrev_b32 v11, 5, v2
    ds_read_b128 v[96:99], v11 offset:0
    ds_read_b128 v[100:103], v11 offset:16
    ds_read_b128 v[104:107], v11 offset:1024
    ds_read_b128 v[108:111], v11 offset:1040
    ds_read_b128 v[112:115], v11 offset:2048
    ds_read_b128 v[116:119], v11 offset:2064
    ds_read_b128 v[120:123], v11 offset:3072
    ds_read_b128 v[124:127], v11 offset:3088
    v_mov_b32 v128, 0
    v_mov_b32 v129, 0
    v_mov_b32 v130, 0
    v_mov_b32 v131, 0
    v_mov_b32 v132, 0
    v_mov_b32 v133, 0
    v_mov_b32 v134, 0
    v_mov_b32 v135, 0
    v_mov_b32 v136, 0
    v_mov_b32 v137, 0
    v_mov_b32 v138, 0
    v_mov_b32 v139, 0
    v_mov_b32 v140, 0
    v_mov_b32 v141, 0
    v_mov_b32 v142, 0
    v_mov_b32 v143, 0
    v_mov_b32 v144, 0
    v_mov_b32 v145, 0
    v_mov_b32 v146, 0
    v_mov_b32 v147, 0
    v_mov_b32 v148, 0
    v_mov_b32 v149, 0
    v_mov_b32 v150, 0
    v_mov_b32 v151, 0
    v_mov_b32 v152, 0
    v_mov_b32 v153, 0
    v_mov_b32 v154, 0
    v_mov_b32 v155, 0
    v_mov_b32 v156, 0
    v_mov_b32 v157, 0
    v_mov_b32 v158, 0
    v_mov_b32 v159, 0
    s_waitcnt lgkmcnt(0)
    s_waitcnt vmcnt(7)
    v_lshlrev_b32 v160, 16, v64
    v_and_b32 v161, 0xffff0000, v64
    v_lshlrev_b32 v162, 16, v65
    v_and_b32 v163, 0xffff0000, v65
    v_lshlrev_b32 v164, 16, v66
    v_and_b32 v165, 0xffff0000, v66
    v_lshlrev_b32 v166, 16, v67
    v_and_b32 v167, 0xffff0000, v67
    v_pk_fma_f32 v[128:129], v[160:161], v[96:97], v[128:129] op_sel:[0,0,0] op_sel_hi:[1,0,1]
    v_pk_fma_f32 v[130:131], v[162:163], v[96:97], v[130:131] op_sel:[0,0,0] op_sel_hi:[1,0,1]
    v_pk_fma_f32 v[132:133], v[164:165], v[96:97], v[132:133] op_sel:[0,0,0] op_sel_hi:[1,0,1]
    v_pk_fma_f32 v[134:135], v[166:167], v[96:97], v[134:135] op_sel:[0,0,0] op_sel_hi:[1,0,1]
    v_pk_fma_f32 v[136:137], v[160:161], v[104:105], v[136:137] op_sel:[0,0,0] op_sel_hi:[1,0,1]
    v_pk_fma_f32 v[138:139], v[162:163], v[104:105], v[138:139] op_sel:[0,0,0] op_sel_hi:[1,0,1]
    v_pk_fma_f32 v[140:141], v[164:165], v[104:105], v[140:141] op_sel:[0,0,0] op_sel_hi:[1,0,1]
    v_pk_fma_f32 v[142:143], v[166:167], v[104:105], v[142:143] op_sel:[0,0,0] op_sel_hi:[1,0,1]
    v_pk_fma_f32 v[144:145], v[160:161], v[112:113], v[144:145] op_sel:[0,0,0] op_sel_hi:[1,0,1]
    v_pk_fma_f32 v[146:147], v[162:163], v[112:113], v[146:147] op_sel:[0,0,0] op_sel_hi:[1,0,1]
    v_pk_fma_f32 v[148:149], v[164:165], v[112:113], v[148:149] op_sel:[0,0,0] op_sel_hi:[1,0,1]
    v_pk_fma_f32 v[150:151], v[166:167], v[112:113], v[150:151] op_sel:[0,0,0] op_sel_hi:[1,0,1]
    v_pk_fma_f32 v[152:153], v[160:161], v[120:121], v[152:153] op_sel:[0,0,0] op_sel_hi:[1,0,1]
    v_pk_fma_f32 v[154:155], v[162:163], v[120:121], v[154:155] op_sel:[0,0,0] op_sel_hi:[1,0,1]
    v_pk_fma_f32 v[156:157], v[164:165], v[120:121], v[156:157] op_sel:[0,0,0] op_sel_hi:[1,0,1]
    v_pk_fma_f32 v[158:159], v[166:167], v[120:121], v[158:159] op_sel:[0,0,0] op_sel_hi:[1,0,1]
    s_waitcnt vmcnt(6)
    v_lshlrev_b32 v160, 16, v68
    v_and_b32 v161, 0xffff0000, v68
    v_lshlrev_b32 v162, 16, v69
    v_and_b32 v163, 0xffff0000, v69
    v_lshlrev_b32 v164, 16, v70
    v_and_b32 v165, 0xffff0000, v70
    v_lshlrev_b32 v166, 16, v71
    v_and_b32 v167, 0xffff0000, v71
    v_pk_fma_f32 v[128:129], v[160:161], v[96:97], v[128:129] op_sel:[0,1,0] op_sel_hi:[1,1,1]
    v_pk_fma_f32 v[130:131], v[162:163], v[96:97], v[130:131] op_sel:[0,1,0] op_sel_hi:[1,1,1]
    v_pk_fma_f32 v[132:133], v[164:165], v[96:97], v[132:133] op_sel:[0,1,0] op_sel_hi:[1,1,1]
    v_pk_fma_f32 v[134:135], v[166:167], v[96:97], v[134:135] op_sel:[0,1,0] op_sel_hi:[1,1,1]
    v_pk_fma_f32 v[136:137], v[160:161], v[104:105], v[136:137] op_sel:[0,1,0] op_sel_hi:[1,1,1]
    v_pk_fma_f32 v[138:139], v[162:163], v[104:105], v[138:139] op_sel:[0,1,0] op_sel_hi:[1,1,1]
    v_pk_fma_f32 v[140:141], v[164:165], v[104:105], v[140:141] op_sel:[0,1,0] op_sel_hi:[1,1,1]
    v_pk_fma_f32 v[142:143], v[166:167], v[104:105], v[142:143] op_sel:[0,1,0] op_sel_hi:[1,1,1]
    v_pk_fma_f32 v[144:145], v[160:161], v[112:113], v[144:145] op_sel:[0,1,0] op_sel_hi:[1,1,1]
    v_pk_fma_f32 v[146:147], v[162:163], v[112:113], v[146:147] op_sel:[0,1,0] op_sel_hi:[1,1,1]
    v_pk_fma_f32 v[148:149], v[164:165], v[112:113], v[148:149] op_sel:[0,1,0] op_sel_hi:[1,1,1]
    v_pk_fma_f32 v[150:151], v[166:167], v[112:113], v[150:151] op_sel:[0,1,0] op_sel_hi:[1,1,1]
    v_pk_fma_f32 v[152:153], v[160:161], v[120:121], v[152:153] op_sel:[0,1,0] op_sel_hi:[1,1,1]
    v_pk_fma_f32 v[154:155], v[162:163], v[120:121], v[154:155] op_sel:[0,1,0] op_sel_hi:[1,1,1]
    v_pk_fma_f32 v[156:157], v[164:165], v[120:121], v[156:157] op_sel:[0,1,0] op_sel_hi:[1,1,1]
    v_pk_fma_f32 v[158:159], v[166:167], v[120:121], v[158:159] op_sel:[0,1,0] op_sel_hi:[1,1,1]
    s_waitcnt vmcnt(5)
    v_lshlrev_b32 v160, 16, v72
    v_and_b32 v161, 0xffff0000, v72
    v_lshlrev_b32 v162, 16, v73
    v_and_b32 v163, 0xffff0000, v73
    v_lshlrev_b32 v164, 16, v74
    v_and_b32 v165, 0xffff0000, v74
    v_lshlrev_b32 v166, 16, v75
    v_and_b32 v167, 0xffff0000, v75
    v_pk_fma_f32 v[128:129], v[160:161], v[98:99], v[128:129] op_sel:[0,0,0] op_sel_hi:[1,0,1]
    v_pk_fma_f32 v[130:131], v[162:163], v[98:99], v[130:131] op_sel:[0,0,0] op_sel_hi:[1,0,1]
    v_pk_fma_f32 v[132:133], v[164:165], v[98:99], v[132:133] op_sel:[0,0,0] op_sel_hi:[1,0,1]
    v_pk_fma_f32 v[134:135], v[166:167], v[98:99], v[134:135] op_sel:[0,0,0] op_sel_hi:[1,0,1]
    v_pk_fma_f32 v[136:137], v[160:161], v[106:107], v[136:137] op_sel:[0,0,0] op_sel_hi:[1,0,1]
    v_pk_fma_f32 v[138:139], v[162:163], v[106:107], v[138:139] op_sel:[0,0,0] op_sel_hi:[1,0,1]
    v_pk_fma_f32 v[140:141], v[164:165], v[106:107], v[140:141] op_sel:[0,0,0] op_sel_hi:[1,0,1]
    v_pk_fma_f32 v[142:143], v[166:167], v[106:107], v[142:143] op_sel:[0,0,0] op_sel_hi:[1,0,1]
    v_pk_fma_f32 v[144:145], v[160:161], v[114:115], v[144:145] op_sel:[0,0,0] op_sel_hi:[1,0,1]
    v_pk_fma_f32 v[146:147], v[162:163], v[114:115], v[146:147] op_sel:[0,0,0] op_sel_hi:[1,0,1]
    v_pk_fma_f32 v[148:149], v[164:165], v[114:115], v[148:149] op_sel:[0,0,0] op_sel_hi:[1,0,1]
    v_pk_fma_f32 v[150:151], v[166:167], v[114:115], v[150:151] op_sel:[0,0,0] op_sel_hi:[1,0,1]
    v_pk_fma_f32 v[152:153], v[160:161], v[122:123], v[152:153] op_sel:[0,0,0] op_sel_hi:[1,0,1]
    v_pk_fma_f32 v[154:155], v[162:163], v[122:123], v[154:155] op_sel:[0,0,0] op_sel_hi:[1,0,1]
    v_pk_fma_f32 v[156:157], v[164:165], v[122:123], v[156:157] op_sel:[0,0,0] op_sel_hi:[1,0,1]
    v_pk_fma_f32 v[158:159], v[166:167], v[122:123], v[158:159] op_sel:[0,0,0] op_sel_hi:[1,0,1]
    s_waitcnt vmcnt(4)
    v_lshlrev_b32 v160, 16, v76
    v_and_b32 v161, 0xffff0000, v76
    v_lshlrev_b32 v162, 16, v77
    v_and_b32 v163, 0xffff0000, v77
    v_lshlrev_b32 v164, 16, v78
    v_and_b32 v165, 0xffff0000, v78
    v_lshlrev_b32 v166, 16, v79
    v_and_b32 v167, 0xffff0000, v79
    v_pk_fma_f32 v[128:129], v[160:161], v[98:99], v[128:129] op_sel:[0,1,0] op_sel_hi:[1,1,1]
    v_pk_fma_f32 v[130:131], v[162:163], v[98:99], v[130:131] op_sel:[0,1,0] op_sel_hi:[1,1,1]
    v_pk_fma_f32 v[132:133], v[164:165], v[98:99], v[132:133] op_sel:[0,1,0] op_sel_hi:[1,1,1]
    v_pk_fma_f32 v[134:135], v[166:167], v[98:99], v[134:135] op_sel:[0,1,0] op_sel_hi:[1,1,1]
    v_pk_fma_f32 v[136:137], v[160:161], v[106:107], v[136:137] op_sel:[0,1,0] op_sel_hi:[1,1,1]
    v_pk_fma_f32 v[138:139], v[162:163], v[106:107], v[138:139] op_sel:[0,1,0] op_sel_hi:[1,1,1]
    v_pk_fma_f32 v[140:141], v[164:165], v[106:107], v[140:141] op_sel:[0,1,0] op_sel_hi:[1,1,1]
    v_pk_fma_f32 v[142:143], v[166:167], v[106:107], v[142:143] op_sel:[0,1,0] op_sel_hi:[1,1,1]
    v_pk_fma_f32 v[144:145], v[160:161], v[114:115], v[144:145] op_sel:[0,1,0] op_sel_hi:[1,1,1]
    v_pk_fma_f32 v[146:147], v[162:163], v[114:115], v[146:147] op_sel:[0,1,0] op_sel_hi:[1,1,1]
    v_pk_fma_f32 v[148:149], v[164:165], v[114:115], v[148:149] op_sel:[0,1,0] op_sel_hi:[1,1,1]
    v_pk_fma_f32 v[150:151], v[166:167], v[114:115], v[150:151] op_sel:[0,1,0] op_sel_hi:[1,1,1]
    v_pk_fma_f32 v[152:153], v[160:161], v[122:123], v[152:153] op_sel:[0,1,0] op_sel_hi:[1,1,1]
    v_pk_fma_f32 v[154:155], v[162:163], v[122:123], v[154:155] op_sel:[0,1,0] op_sel_hi:[1,1,1]
    v_pk_fma_f32 v[156:157], v[164:165], v[122:123], v[156:157] op_sel:[0,1,0] op_sel_hi:[1,1,1]
    v_pk_fma_f32 v[158:159], v[166:167], v[122:123], v[158:159] op_sel:[0,1,0] op_sel_hi:[1,1,1]
    s_waitcnt vmcnt(3)
    v_lshlrev_b32 v160, 16, v80
    v_and_b32 v161, 0xffff0000, v80
    v_lshlrev_b32 v162, 16, v81
    v_and_b32 v163, 0xffff0000, v81
    v_lshlrev_b32 v164, 16, v82
    v_and_b32 v165, 0xffff0000, v82
    v_lshlrev_b32 v166, 16, v83
    v_and_b32 v167, 0xffff0000, v83
    v_pk_fma_f32 v[128:129], v[160:161], v[100:101], v[128:129] op_sel:[0,0,0] op_sel_hi:[1,0,1]
    v_pk_fma_f32 v[130:131], v[162:163], v[100:101], v[130:131] op_sel:[0,0,0] op_sel_hi:[1,0,1]
    v_pk_fma_f32 v[132:133], v[164:165], v[100:101], v[132:133] op_sel:[0,0,0] op_sel_hi:[1,0,1]
    v_pk_fma_f32 v[134:135], v[166:167], v[100:101], v[134:135] op_sel:[0,0,0] op_sel_hi:[1,0,1]
    v_pk_fma_f32 v[136:137], v[160:161], v[108:109], v[136:137] op_sel:[0,0,0] op_sel_hi:[1,0,1]
    v_pk_fma_f32 v[138:139], v[162:163], v[108:109], v[138:139] op_sel:[0,0,0] op_sel_hi:[1,0,1]
    v_pk_fma_f32 v[140:141], v[164:165], v[108:109], v[140:141] op_sel:[0,0,0] op_sel_hi:[1,0,1]
    v_pk_fma_f32 v[142:143], v[166:167], v[108:109], v[142:143] op_sel:[0,0,0] op_sel_hi:[1,0,1]
    v_pk_fma_f32 v[144:145], v[160:161], v[116:117], v[144:145] op_sel:[0,0,0] op_sel_hi:[1,0,1]
    v_pk_fma_f32 v[146:147], v[162:163], v[116:117], v[146:147] op_sel:[0,0,0] op_sel_hi:[1,0,1]
    v_pk_fma_f32 v[148:149], v[164:165], v[116:117], v[148:149] op_sel:[0,0,0] op_sel_hi:[1,0,1]
    v_pk_fma_f32 v[150:151], v[166:167], v[116:117], v[150:151] op_sel:[0,0,0] op_sel_hi:[1,0,1]
    v_pk_fma_f32 v[152:153], v[160:161], v[124:125], v[152:153] op_sel:[0,0,0] op_sel_hi:[1,0,1]
    v_pk_fma_f32 v[154:155], v[162:163], v[124:125], v[154:155] op_sel:[0,0,0] op_sel_hi:[1,0,1]
    v_pk_fma_f32 v[156:157], v[164:165], v[124:125], v[156:157] op_sel:[0,0,0] op_sel_hi:[1,0,1]
    v_pk_fma_f32 v[158:159], v[166:167], v[124:125], v[158:159] op_sel:[0,0,0] op_sel_hi:[1,0,1]
    s_waitcnt vmcnt(2)
    v_lshlrev_b32 v160, 16, v84
    v_and_b32 v161, 0xffff0000, v84
    v_lshlrev_b32 v162, 16, v85
    v_and_b32 v163, 0xffff0000, v85
    v_lshlrev_b32 v164, 16, v86
    v_and_b32 v165, 0xffff0000, v86
    v_lshlrev_b32 v166, 16, v87
    v_and_b32 v167, 0xffff0000, v87
    v_pk_fma_f32 v[128:129], v[160:161], v[100:101], v[128:129] op_sel:[0,1,0] op_sel_hi:[1,1,1]
    v_pk_fma_f32 v[130:131], v[162:163], v[100:101], v[130:131] op_sel:[0,1,0] op_sel_hi:[1,1,1]
    v_pk_fma_f32 v[132:133], v[164:165], v[100:101], v[132:133] op_sel:[0,1,0] op_sel_hi:[1,1,1]
    v_pk_fma_f32 v[134:135], v[166:167], v[100:101], v[134:135] op_sel:[0,1,0] op_sel_hi:[1,1,1]
    v_pk_fma_f32 v[136:137], v[160:161], v[108:109], v[136:137] op_sel:[0,1,0] op_sel_hi:[1,1,1]
    v_pk_fma_f32 v[138:139], v[162:163], v[108:109], v[138:139] op_sel:[0,1,0] op_sel_hi:[1,1,1]
    v_pk_fma_f32 v[140:141], v[164:165], v[108:109], v[140:141] op_sel:[0,1,0] op_sel_hi:[1,1,1]
    v_pk_fma_f32 v[142:143], v[166:167], v[108:109], v[142:143] op_sel:[0,1,0] op_sel_hi:[1,1,1]
    v_pk_fma_f32 v[144:145], v[160:161], v[116:117], v[144:145] op_sel:[0,1,0] op_sel_hi:[1,1,1]
    v_pk_fma_f32 v[146:147], v[162:163], v[116:117], v[146:147] op_sel:[0,1,0] op_sel_hi:[1,1,1]
    v_pk_fma_f32 v[148:149], v[164:165], v[116:117], v[148:149] op_sel:[0,1,0] op_sel_hi:[1,1,1]
    v_pk_fma_f32 v[150:151], v[166:167], v[116:117], v[150:151] op_sel:[0,1,0] op_sel_hi:[1,1,1]
    v_pk_fma_f32 v[152:153], v[160:161], v[124:125], v[152:153] op_sel:[0,1,0] op_sel_hi:[1,1,1]
    v_pk_fma_f32 v[154:155], v[162:163], v[124:125], v[154:155] op_sel:[0,1,0] op_sel_hi:[1,1,1]
    v_pk_fma_f32 v[156:157], v[164:165], v[124:125], v[156:157] op_sel:[0,1,0] op_sel_hi:[1,1,1]
    v_pk_fma_f32 v[158:159], v[166:167], v[124:125], v[158:159] op_sel:[0,1,0] op_sel_hi:[1,1,1]
    s_waitcnt vmcnt(1)
    v_lshlrev_b32 v160, 16, v88
    v_and_b32 v161, 0xffff0000, v88
    v_lshlrev_b32 v162, 16, v89
    v_and_b32 v163, 0xffff0000, v89
    v_lshlrev_b32 v164, 16, v90
    v_and_b32 v165, 0xffff0000, v90
    v_lshlrev_b32 v166, 16, v91
    v_and_b32 v167, 0xffff0000, v91
    v_pk_fma_f32 v[128:129], v[160:161], v[102:103], v[128:129] op_sel:[0,0,0] op_sel_hi:[1,0,1]
    v_pk_fma_f32 v[130:131], v[162:163], v[102:103], v[130:131] op_sel:[0,0,0] op_sel_hi:[1,0,1]
    v_pk_fma_f32 v[132:133], v[164:165], v[102:103], v[132:133] op_sel:[0,0,0] op_sel_hi:[1,0,1]
    v_pk_fma_f32 v[134:135], v[166:167], v[102:103], v[134:135] op_sel:[0,0,0] op_sel_hi:[1,0,1]
    v_pk_fma_f32 v[136:137], v[160:161], v[110:111], v[136:137] op_sel:[0,0,0] op_sel_hi:[1,0,1]
    v_pk_fma_f32 v[138:139], v[162:163], v[110:111], v[138:139] op_sel:[0,0,0] op_sel_hi:[1,0,1]
    v_pk_fma_f32 v[140:141], v[164:165], v[110:111], v[140:141] op_sel:[0,0,0] op_sel_hi:[1,0,1]
    v_pk_fma_f32 v[142:143], v[166:167], v[110:111], v[142:143] op_sel:[0,0,0] op_sel_hi:[1,0,1]
    v_pk_fma_f32 v[144:145], v[160:161], v[118:119], v[144:145] op_sel:[0,0,0] op_sel_hi:[1,0,1]
    v_pk_fma_f32 v[146:147], v[162:163], v[118:119], v[146:147] op_sel:[0,0,0] op_sel_hi:[1,0,1]
    v_pk_fma_f32 v[148:149], v[164:165], v[118:119], v[148:149] op_sel:[0,0,0] op_sel_hi:[1,0,1]
    v_pk_fma_f32 v[150:151], v[166:167], v[118:119], v[150:151] op_sel:[0,0,0] op_sel_hi:[1,0,1]
    v_pk_fma_f32 v[152:153], v[160:161], v[126:127], v[152:153] op_sel:[0,0,0] op_sel_hi:[1,0,1]
    v_pk_fma_f32 v[154:155], v[162:163], v[126:127], v[154:155] op_sel:[0,0,0] op_sel_hi:[1,0,1]
    v_pk_fma_f32 v[156:157], v[164:165], v[126:127], v[156:157] op_sel:[0,0,0] op_sel_hi:[1,0,1]
    v_pk_fma_f32 v[158:159], v[166:167], v[126:127], v[158:159] op_sel:[0,0,0] op_sel_hi:[1,0,1]
    s_waitcnt vmcnt(0)
    v_lshlrev_b32 v160, 16, v92
    v_and_b32 v161, 0xffff0000, v92
    v_lshlrev_b32 v162, 16, v93
    v_and_b32 v163, 0xffff0000, v93
    v_lshlrev_b32 v164, 16, v94
    v_and_b32 v165, 0xffff0000, v94
    v_lshlrev_b32 v166, 16, v95
    v_and_b32 v167, 0xffff0000, v95
    v_pk_fma_f32 v[128:129], v[160:161], v[102:103], v[128:129] op_sel:[0,1,0] op_sel_hi:[1,1,1]
    v_pk_fma_f32 v[130:131], v[162:163], v[102:103], v[130:131] op_sel:[0,1,0] op_sel_hi:[1,1,1]
    v_pk_fma_f32 v[132:133], v[164:165], v[102:103], v[132:133] op_sel:[0,1,0] op_sel_hi:[1,1,1]
    v_pk_fma_f32 v[134:135], v[166:167], v[102:103], v[134:135] op_sel:[0,1,0] op_sel_hi:[1,1,1]
    v_pk_fma_f32 v[136:137], v[160:161], v[110:111], v[136:137] op_sel:[0,1,0] op_sel_hi:[1,1,1]
    v_pk_fma_f32 v[138:139], v[162:163], v[110:111], v[138:139] op_sel:[0,1,0] op_sel_hi:[1,1,1]
    v_pk_fma_f32 v[140:141], v[164:165], v[110:111], v[140:141] op_sel:[0,1,0] op_sel_hi:[1,1,1]
    v_pk_fma_f32 v[142:143], v[166:167], v[110:111], v[142:143] op_sel:[0,1,0] op_sel_hi:[1,1,1]
    v_pk_fma_f32 v[144:145], v[160:161], v[118:119], v[144:145] op_sel:[0,1,0] op_sel_hi:[1,1,1]
    v_pk_fma_f32 v[146:147], v[162:163], v[118:119], v[146:147] op_sel:[0,1,0] op_sel_hi:[1,1,1]
    v_pk_fma_f32 v[148:149], v[164:165], v[118:119], v[148:149] op_sel:[0,1,0] op_sel_hi:[1,1,1]
    v_pk_fma_f32 v[150:151], v[166:167], v[118:119], v[150:151] op_sel:[0,1,0] op_sel_hi:[1,1,1]
    v_pk_fma_f32 v[152:153], v[160:161], v[126:127], v[152:153] op_sel:[0,1,0] op_sel_hi:[1,1,1]
    v_pk_fma_f32 v[154:155], v[162:163], v[126:127], v[154:155] op_sel:[0,1,0] op_sel_hi:[1,1,1]
    v_pk_fma_f32 v[156:157], v[164:165], v[126:127], v[156:157] op_sel:[0,1,0] op_sel_hi:[1,1,1]
    v_pk_fma_f32 v[158:159], v[166:167], v[126:127], v[158:159] op_sel:[0,1,0] op_sel_hi:[1,1,1]
    v_lshlrev_b32 v11, 10, v2
    v_lshl_add_u32 v11, v1, 5, v11
    ds_write_b128 v11, v[128:131] offset:4096
    ds_write_b128 v11, v[132:135] offset:4112
    ds_write_b128 v11, v[136:139] offset:4352
    ds_write_b128 v11, v[140:143] offset:4368
    ds_write_b128 v11, v[144:147] offset:4608
    ds_write_b128 v11, v[148:151] offset:4624
    ds_write_b128 v11, v[152:155] offset:4864
    ds_write_b128 v11, v[156:159] offset:4880
    s_waitcnt lgkmcnt(0)
    s_barrier
    v_lshlrev_b32 v11, 2, v0
    ds_read_b32 v16, v11 offset:4096
    ds_read_b32 v17, v11 offset:5120
    ds_read_b32 v18, v11 offset:6144
    ds_read_b32 v19, v11 offset:7168
    ds_read_b32 v20, v11 offset:8192
    ds_read_b32 v21, v11 offset:9216
    ds_read_b32 v22, v11 offset:10240
    ds_read_b32 v23, v11 offset:11264
    ds_read_b32 v24, v11 offset:12288
    ds_read_b32 v25, v11 offset:13312
    ds_read_b32 v26, v11 offset:14336
    ds_read_b32 v27, v11 offset:15360
    ds_read_b32 v28, v11 offset:16384
    ds_read_b32 v29, v11 offset:17408
    ds_read_b32 v30, v11 offset:18432
    ds_read_b32 v31, v11 offset:19456
    ds_read_b32 v32, v11 offset:20480
    ds_read_b32 v33, v11 offset:21504
    ds_read_b32 v34, v11 offset:22528
    ds_read_b32 v35, v11 offset:23552
    ds_read_b32 v36, v11 offset:24576
    ds_read_b32 v37, v11 offset:25600
    ds_read_b32 v38, v11 offset:26624
    ds_read_b32 v39, v11 offset:27648
    ds_read_b32 v40, v11 offset:28672
    ds_read_b32 v41, v11 offset:29696
    ds_read_b32 v42, v11 offset:30720
    ds_read_b32 v43, v11 offset:31744
    ds_read_b32 v44, v11 offset:32768
    ds_read_b32 v45, v11 offset:33792
    ds_read_b32 v46, v11 offset:34816
    ds_read_b32 v47, v11 offset:35840
    s_waitcnt lgkmcnt(15)
    v_add_f32 v16, v16, v17
    s_waitcnt lgkmcnt(15)
    v_add_f32 v16, v16, v18
    s_waitcnt lgkmcnt(15)
    v_add_f32 v16, v16, v19
    s_waitcnt lgkmcnt(15)
    v_add_f32 v16, v16, v20
    s_waitcnt lgkmcnt(15)
    v_add_f32 v16, v16, v21
    s_waitcnt lgkmcnt(15)
    v_add_f32 v16, v16, v22
    s_waitcnt lgkmcnt(15)
    v_add_f32 v16, v16, v23
    s_waitcnt lgkmcnt(15)
    v_add_f32 v16, v16, v24
    s_waitcnt lgkmcnt(15)
    v_add_f32 v16, v16, v25
    s_waitcnt lgkmcnt(15)
    v_add_f32 v16, v16, v26
    s_waitcnt lgkmcnt(15)
    v_add_f32 v16, v16, v27
    s_waitcnt lgkmcnt(15)
    v_add_f32 v16, v16, v28
    s_waitcnt lgkmcnt(15)
    v_add_f32 v16, v16, v29
    s_waitcnt lgkmcnt(15)
    v_add_f32 v16, v16, v30
    s_waitcnt lgkmcnt(15)
    v_add_f32 v16, v16, v31
    s_waitcnt lgkmcnt(15)
    v_add_f32 v16, v16, v32
    s_waitcnt lgkmcnt(14)
    v_add_f32 v16, v16, v33
    s_waitcnt lgkmcnt(13)
    v_add_f32 v16, v16, v34
    s_waitcnt lgkmcnt(12)
    v_add_f32 v16, v16, v35
    s_waitcnt lgkmcnt(11)
    v_add_f32 v16, v16, v36
    s_waitcnt lgkmcnt(10)
    v_add_f32 v16, v16, v37
    s_waitcnt lgkmcnt(9)
    v_add_f32 v16, v16, v38
    s_waitcnt lgkmcnt(8)
    v_add_f32 v16, v16, v39
    s_waitcnt lgkmcnt(7)
    v_add_f32 v16, v16, v40
    s_waitcnt lgkmcnt(6)
    v_add_f32 v16, v16, v41
    s_waitcnt lgkmcnt(5)
    v_add_f32 v16, v16, v42
    s_waitcnt lgkmcnt(4)
    v_add_f32 v16, v16, v43
    s_waitcnt lgkmcnt(3)
    v_add_f32 v16, v16, v44
    s_waitcnt lgkmcnt(2)
    v_add_f32 v16, v16, v45
    s_waitcnt lgkmcnt(1)
    v_add_f32 v16, v16, v46
    s_waitcnt lgkmcnt(0)
    v_add_f32 v16, v16, v47
    s_lshl_b32 s19, s14, 4
    s_add_u32 s19, s19, s15
    s_lshl_b32 s19, s19, 13
    s_lshl_b32 s20, s16, 8
    s_add_u32 s19, s19, s20
    s_add_u32 s19, s19, 3145728
    v_lshlrev_b32 v8, 11, v5
    v_lshl_add_u32 v8, v6, 2, v8
    v_add_u32 v9, s19, v8
    global_store_dword v9, v16, s[12:13] sc1
    s_waitcnt vmcnt(0)
    s_barrier
    s_lshl_b32 s21, s14, 3
    s_add_u32 s21, s21, s16
    s_lshl_b32 s21, s21, 2
    v_mov_b32 v10, s21
    v_mov_b32 v11, 1
    v_cmp_eq_u32 vcc, 0, v0
    s_and_saveexec_b64 s[30:31], vcc
    global_atomic_add v12, v10, v11, s[10:11] sc0 sc1
    v_mov_b32 v13, 0
    s_waitcnt vmcnt(0)
    ds_write_b32 v13, v12
    s_mov_b64 exec, s[30:31]
    s_waitcnt lgkmcnt(0)
    s_barrier
    v_mov_b32 v13, 0
    ds_read_b32 v12, v13
    s_waitcnt lgkmcnt(0)
    v_readfirstlane_b32 s22, v12
    s_nop 3
    s_cmp_lg_u32 s22, 15
    s_cbranch_scc1 L_o_end
    s_lshl_b32 s19, s14, 17
    s_add_u32 s19, s19, s20
    s_add_u32 s19, s19, 3145728
    v_add_u32 v9, s19, v8
    v_add_u32 v10, 0x8000, v9
    v_add_u32 v11, 0x10000, v9
    v_add_u32 v12, 0x18000, v9
    global_load_dword v16, v9, s[12:13] offset:0 sc1
    v_add_u32 v13, 8192, v9
    global_load_dword v17, v13, s[12:13] sc1
    v_add_u32 v13, 16384, v9
    global_load_dword v18, v13, s[12:13] sc1
    v_add_u32 v13, 24576, v9
    global_load_dword v19, v13, s[12:13] sc1
    global_load_dword v20, v10, s[12:13] offset:0 sc1
    v_add_u32 v13, 8192, v10
    global_load_dword v21, v13, s[12:13] sc1
    v_add_u32 v13, 16384, v10
    global_load_dword v22, v13, s[12:13] sc1
    v_add_u32 v13, 24576, v10
    global_load_dword v23, v13, s[12:13] sc1
    global_load_dword v24, v11, s[12:13] offset:0 sc1
    v_add_u32 v13, 8192, v11
    global_load_dword v25, v13, s[12:13] sc1
    v_add_u32 v13, 16384, v11
    global_load_dword v26, v13, s[12:13] sc1
    v_add_u32 v13, 24576, v11
    global_load_dword v27, v13, s[12:13] sc1
    global_load_dword v28, v12, s[12:13] offset:0 sc1
    v_add_u32 v13, 8192, v12
    global_load_dword v29, v13, s[12:13] sc1
    v_add_u32 v13, 16384, v12
    global_load_dword v30, v13, s[12:13] sc1
    v_add_u32 v13, 24576, v12
    global_load_dword v31, v13, s[12:13] sc1
    s_waitcnt vmcnt(14)
    v_add_f32 v16, v16, v17
    s_waitcnt vmcnt(13)
    v_add_f32 v16, v16, v18
    s_waitcnt vmcnt(12)
    v_add_f32 v16, v16, v19
    s_waitcnt vmcnt(11)
    v_add_f32 v16, v16, v20
    s_waitcnt vmcnt(10)
    v_add_f32 v16, v16, v21
    s_waitcnt vmcnt(9)
    v_add_f32 v16, v16, v22
    s_waitcnt vmcnt(8)
    v_add_f32 v16, v16, v23
    s_waitcnt vmcnt(7)
    v_add_f32 v16, v16, v24
    s_waitcnt vmcnt(6)
    v_add_f32 v16, v16, v25
    s_waitcnt vmcnt(5)
    v_add_f32 v16, v16, v26
    s_waitcnt vmcnt(4)
    v_add_f32 v16, v16, v27
    s_waitcnt vmcnt(3)
    v_add_f32 v16, v16, v28
    s_waitcnt vmcnt(2)
    v_add_f32 v16, v16, v29
    s_waitcnt vmcnt(1)
    v_add_f32 v16, v16, v30
    s_waitcnt vmcnt(0)
    v_add_f32 v16, v16, v31
    v_cvt_pk_bf16_f32 v16, v16, v16
    s_lshl_b32 s19, s14, 10
    s_lshl_b32 s20, s16, 7
    s_add_u32 s19, s19, s20
    v_lshlrev_b32 v9, 11, v5
    v_lshl_add_u32 v9, v6, 1, v9
    v_add_u32 v9, s19, v9
    global_store_short v9, v16, s[8:9]
L_o_end:
    s_endpgm
.section .rodata,"a"
.p2align 6
.amdhsa_kernel qproj_kernel
  .amdhsa_next_free_vgpr 136
  .amdhsa_next_free_sgpr 32
  .amdhsa_accum_offset 136
  .amdhsa_group_segment_fixed_size 0
  .amdhsa_kernarg_size 104
  .amdhsa_user_sgpr_count 2
  .amdhsa_user_sgpr_kernarg_segment_ptr 1
  .amdhsa_system_sgpr_workgroup_id_x 1
.end_amdhsa_kernel
.p2align 6
.amdhsa_kernel attn_kernel
  .amdhsa_next_free_vgpr 232
  .amdhsa_next_free_sgpr 64
  .amdhsa_accum_offset 232
  .amdhsa_group_segment_fixed_size 0
  .amdhsa_kernarg_size 104
  .amdhsa_user_sgpr_count 2
  .amdhsa_user_sgpr_kernarg_segment_ptr 1
  .amdhsa_system_sgpr_workgroup_id_x 1
.end_amdhsa_kernel
.p2align 6
.amdhsa_kernel oproj_kernel
  .amdhsa_next_free_vgpr 168
  .amdhsa_next_free_sgpr 40
  .amdhsa_accum_offset 168
  .amdhsa_group_segment_fixed_size 0
  .amdhsa_kernarg_size 104
  .amdhsa_user_sgpr_count 2
  .amdhsa_user_sgpr_kernarg_segment_ptr 1
  .amdhsa_system_sgpr_workgroup_id_x 1
.end_amdhsa_kernel
```
